```python
import torch

def _softmax(x, axis=-1):
    return torch.softmax(x, dim=axis)
def _gelu(x):
    return torch.nn.functional.gelu(x, approximate="tanh")
def _silu(x):
    return torch.nn.functional.silu(x)
def _sigmoid(x):
    return torch.sigmoid(x)
def _layernorm(x, axis=-1, eps=1e-5):
    m = x.mean(dim=axis, keepdim=True)
    v = x.var(dim=axis, keepdim=True, unbiased=False)
    return (x - m) / torch.sqrt(v + eps)
def _scatter_add(tgt, idx, src, axis=0):
    return tgt.clone().index_add_(axis, idx, src)
def _segment_sum(src, seg, n):
    out = torch.zeros((n,) + src.shape[1:], dtype=src.dtype)
    return out.index_add_(0, seg, src)
def _pad(x, pw):
    flat = tuple(v for pair in reversed(pw) for v in pair)
    return torch.nn.functional.pad(x, flat)

kernel_name = 'parallel_sum__mha_block_cached__dense_activation_squared_relu__decode'

def setup_inputs():

    _w = (lambda a: (lambda t: t.to(torch.bfloat16) if t.is_floating_point() else t)(torch.as_tensor(a)))
    def _A_setup():
        B, Sq, D = 1, 1, 512
        H, Sk, Dh = 32, 65536, 128
        return {
            "x": _w((lambda *s: torch.randn(*s, dtype=torch.bfloat16) * 0.05)(B, Sq, D)),
            "k_cache": _w((lambda *s: torch.randn(*s, dtype=torch.bfloat16) * 3.2)(B, H, Sk, Dh)),
            "v_cache": _w((lambda *s: torch.randn(*s, dtype=torch.bfloat16) * 1.6)(B, H, Sk, Dh)),
            "wq": _w((lambda *s: torch.randn(*s, dtype=torch.bfloat16) * 3.2)(D, H * Dh) * (D ** -0.5)),
            "wo": _w((lambda *s: torch.randn(*s, dtype=torch.bfloat16) * 1.6)(H * Dh, D) * ((H * Dh) ** -0.5)),
        }
    _A_in = _A_setup()

    def _B_setup():
        B, S, D, F = 1, 1, 512, 1792
        return {
            "x": _w((lambda *s: torch.randn(*s, dtype=torch.bfloat16) * 0.05)(B, S, D)),
            "w1": _w((lambda *s: torch.randn(*s, dtype=torch.bfloat16) * 0.05)(D, F)),
            "b1": _w((lambda *s: torch.randn(*s, dtype=torch.bfloat16) * 0.05)(F)),
            "w2": _w((lambda *s: torch.randn(*s, dtype=torch.bfloat16) * 0.05)(F, D)),
            "b2": _w((lambda *s: torch.randn(*s, dtype=torch.bfloat16) * 0.05)(D)),
        }
    _B_in = _B_setup()

    return {
        "A_x": _A_in["x"],
        "A_k_cache": _A_in["k_cache"],
        "A_v_cache": _A_in["v_cache"],
        "A_wq": _A_in["wq"],
        "A_wo": _A_in["wo"],
        "B_x": _B_in["x"],
        "B_w1": _B_in["w1"],
        "B_b1": _B_in["b1"],
        "B_w2": _B_in["w2"],
        "B_b2": _B_in["b2"],
    }

def reference(A_x, A_k_cache, A_v_cache, A_wq, A_wo, B_x, B_w1, B_b1, B_w2, B_b2):
    def _A_ref(x, k_cache, v_cache, wq, wo):
        B, Sq, D = x.shape
        H, Dh = 32, 128
        q = (lambda x, *d: x.permute(*d))((x @ wq).reshape(B, Sq, H, Dh), 0, 2, 1, 3)
        scores = torch.einsum("bhqd,bhkd->bhqk", q, k_cache) * (Dh ** -0.5)
        p = _softmax(scores, axis=-1)
        o = torch.einsum("bhqk,bhkd->bhqd", p, v_cache)
        return (lambda x, *d: x.permute(*d))(o, 0, 2, 1, 3).reshape(B, Sq, H * Dh) @ wo

    def _B_ref(x, w1, b1, w2, b2):
        h = torch.einsum("bsd,df->bsf", x, w1) + b1
        zero = torch.zeros_like(h)
        r = torch.where(h > zero, h, zero)
        h = r * r
        out = torch.einsum("bsf,fd->bsd", h, w2) + b2
        return out

    x = A_x
    xn = _layernorm(x, axis=-1)
    return x + _A_ref(xn, A_k_cache, A_v_cache, A_wq, A_wo) + _B_ref(xn, B_w1, B_b1, B_w2, B_b2)
```

```asm
; @launch grid=(256,1,1) block=(512,1,1) lds=40960
.amdgcn_target "amdgcn-amd-amdhsa--gfx950"
.text
.globl parallel_sum__mha_block_cached__dense_activation_squared_relu__decode_kernel
.p2align 8
.type parallel_sum__mha_block_cached__dense_activation_squared_relu__decode_kernel,@function
parallel_sum__mha_block_cached__dense_activation_squared_relu__decode_kernel:
  s_cmp_ge_u32 s2, 256
  s_cbranch_scc1 L_end
  s_load_dwordx16 s[16:31], s[0:1], 0
  s_load_dwordx8 s[32:39], s[0:1], 64
  s_load_dwordx2 s[40:41], s[0:1], 96
  v_lshrrev_b32 v1, 6, v0
  v_and_b32 v0, 63, v0
  v_readfirstlane_b32 s3, v1
  v_and_b32 v1, 15, v0
  v_lshrrev_b32 v2, 4, v0
  s_and_b32 s4, s2, 7
  s_lshl_b32 s4, s4, 2
  s_lshr_b32 s5, s2, 3
  s_and_b32 s6, s5, 3
  s_add_u32 s4, s4, s6
  s_lshr_b32 s5, s2, 5
  v_lshrrev_b32 v3, 1, v1
  v_and_b32 v8, 1, v1
  v_mov_b32 v9, 0xffff
  v_lshlrev_b32 v8, 4, v8
  v_lshlrev_b32 v9, v8, v9
  v_cmp_eq_u32 vcc, 0, v3
  s_nop 1
  v_cndmask_b32 v4, 0, v9, vcc
  v_cmp_eq_u32 vcc, 1, v3
  s_nop 1
  v_cndmask_b32 v5, 0, v9, vcc
  v_cmp_eq_u32 vcc, 2, v3
  s_nop 1
  v_cndmask_b32 v6, 0, v9, vcc
  v_cmp_eq_u32 vcc, 3, v3
  s_nop 1
  v_cndmask_b32 v7, 0, v9, vcc
  s_cmp_ge_u32 s3, 4
  s_cbranch_scc1 L_helper
  s_setprio 2
  s_waitcnt lgkmcnt(0)
  s_lshl_b32 s6, s4, 24
  s_lshl_b32 s7, s5, 21
  s_add_u32 s6, s6, s7
  s_add_u32 s44, s18, s6
  s_addc_u32 s45, s19, 0
  s_and_b32 s45, s45, 0xffff
  s_mov_b32 s46, 0x200000
  s_mov_b32 s47, 0x20000
  s_add_u32 s48, s20, s6
  s_addc_u32 s49, s21, 0
  s_and_b32 s49, s49, 0xffff
  s_mov_b32 s50, 0x200000
  s_mov_b32 s51, 0x20000
  s_lshl_b32 s7, s3, 10
  v_lshlrev_b32 v10, 4, v0
  v_add_u32 v10, s7, v10
  s_mov_b32 s8, 0
  buffer_load_dwordx4 v[64:67], v10, s[44:47], s8 offen nt
  s_add_u32 s8, s8, 4096
  buffer_load_dwordx4 v[68:71], v10, s[44:47], s8 offen nt
  s_add_u32 s8, s8, 4096
  buffer_load_dwordx4 v[72:75], v10, s[44:47], s8 offen nt
  s_add_u32 s8, s8, 4096
  buffer_load_dwordx4 v[76:79], v10, s[44:47], s8 offen nt
  s_add_u32 s8, s8, 4096
  buffer_load_dwordx4 v[80:83], v10, s[44:47], s8 offen nt
  s_add_u32 s8, s8, 4096
  s_mov_b32 s10, 0xaaaaaaaa
  s_mov_b32 s11, 0xaaaaaaaa
  s_mov_b32 s12, 0xcccccccc
  s_mov_b32 s13, 0xcccccccc
  s_mov_b32 s14, 0x3db504f3
  s_mov_b32 s15, 0x3fb8aa3b
  v_mov_b32 v18, 0xff7fffff
  v_mov_b32 v19, 0
  s_lshl_b32 s7, s3, 13
  s_add_u32 s7, s7, 8192
  v_lshlrev_b32 v20, 2, v0
  v_add_u32 v20, s7, v20
  v_mov_b32 v48, 0
  v_mov_b32 v49, 0
  v_mov_b32 v50, 0
  v_mov_b32 v51, 0
  v_lshlrev_b32 v16, 5, v1
  s_cmp_lt_u32 s3, 0
  s_cselect_b64 vcc, -1, 0
  s_waitcnt vmcnt(4)
  buffer_load_dwordx4 v[84:87], v10, s[44:47], s8 offen nt
  s_add_u32 s8, s8, 4096
  s_waitcnt vmcnt(4)
  buffer_load_dwordx4 v[88:91], v10, s[44:47], s8 offen nt
  s_add_u32 s8, s8, 4096
  s_waitcnt vmcnt(4)
  buffer_load_dwordx4 v[92:95], v10, s[44:47], s8 offen nt
  s_add_u32 s8, s8, 4096
  s_waitcnt vmcnt(4)
  buffer_load_dwordx4 v[96:99], v10, s[44:47], s8 offen nt
  s_add_u32 s8, s8, 4096
  s_waitcnt vmcnt(4)
  buffer_load_dwordx4 v[100:103], v10, s[44:47], s8 offen nt
  s_add_u32 s8, s8, 4096
  s_waitcnt vmcnt(4)
  buffer_load_dwordx4 v[104:107], v10, s[44:47], s8 offen nt
  s_add_u32 s8, s8, 4096
  s_waitcnt vmcnt(4)
  buffer_load_dwordx4 v[108:111], v10, s[44:47], s8 offen nt
  s_add_u32 s8, s8, 4096
  s_waitcnt vmcnt(4)
  buffer_load_dwordx4 v[112:115], v10, s[44:47], s8 offen nt
  s_add_u32 s8, s8, 4096
  s_waitcnt vmcnt(4)
  buffer_load_dwordx4 v[116:119], v10, s[44:47], s8 offen nt
  s_add_u32 s8, s8, 4096
  s_waitcnt vmcnt(4)
  buffer_load_dwordx4 v[120:123], v10, s[44:47], s8 offen nt
  s_add_u32 s8, s8, 4096
  s_waitcnt vmcnt(4)
  buffer_load_dwordx4 v[124:127], v10, s[44:47], s8 offen nt
  s_add_u32 s8, s8, 4096
  s_waitcnt vmcnt(4)
  buffer_load_dwordx4 v[128:131], v10, s[44:47], s8 offen nt
  s_add_u32 s8, s8, 4096
  s_waitcnt vmcnt(4)
  buffer_load_dwordx4 v[132:135], v10, s[44:47], s8 offen nt
  s_add_u32 s8, s8, 4096
  s_waitcnt vmcnt(4)
  buffer_load_dwordx4 v[136:139], v10, s[44:47], s8 offen nt
  s_add_u32 s8, s8, 4096
  s_waitcnt vmcnt(4)
  buffer_load_dwordx4 v[140:143], v10, s[44:47], s8 offen nt
  s_add_u32 s8, s8, 4096
  s_waitcnt vmcnt(4)
  buffer_load_dwordx4 v[144:147], v10, s[44:47], s8 offen nt
  s_add_u32 s8, s8, 4096
  s_waitcnt vmcnt(4)
  buffer_load_dwordx4 v[148:151], v10, s[44:47], s8 offen nt
  s_add_u32 s8, s8, 4096
  s_waitcnt vmcnt(4)
  buffer_load_dwordx4 v[152:155], v10, s[44:47], s8 offen nt
  s_add_u32 s8, s8, 4096
  s_waitcnt vmcnt(4)
  buffer_load_dwordx4 v[156:159], v10, s[44:47], s8 offen nt
  s_add_u32 s8, s8, 4096
  s_waitcnt vmcnt(4)
  buffer_load_dwordx4 v[160:163], v10, s[44:47], s8 offen nt
  s_add_u32 s8, s8, 4096
  s_waitcnt vmcnt(4)
  buffer_load_dwordx4 v[164:167], v10, s[44:47], s8 offen nt
  s_add_u32 s8, s8, 4096
  s_waitcnt vmcnt(4)
  buffer_load_dwordx4 v[168:171], v10, s[44:47], s8 offen nt
  s_add_u32 s8, s8, 4096
  s_waitcnt vmcnt(4)
  buffer_load_dwordx4 v[172:175], v10, s[44:47], s8 offen nt
  s_add_u32 s8, s8, 4096
  s_waitcnt vmcnt(4)
  buffer_load_dwordx4 v[176:179], v10, s[44:47], s8 offen nt
  s_add_u32 s8, s8, 4096
  s_waitcnt vmcnt(4)
  buffer_load_dwordx4 v[180:183], v10, s[44:47], s8 offen nt
  s_add_u32 s8, s8, 4096
  s_waitcnt vmcnt(4)
  buffer_load_dwordx4 v[184:187], v10, s[44:47], s8 offen nt
  s_add_u32 s8, s8, 4096
  s_waitcnt vmcnt(4)
  buffer_load_dwordx4 v[188:191], v10, s[44:47], s8 offen nt
  s_add_u32 s8, s8, 4096
  s_waitcnt vmcnt(4)
  buffer_load_dwordx4 v[192:195], v10, s[44:47], s8 offen nt
  s_add_u32 s8, s8, 4096
  s_waitcnt vmcnt(4)
  buffer_load_dwordx4 v[196:199], v10, s[44:47], s8 offen nt
  s_add_u32 s8, s8, 4096
  s_waitcnt vmcnt(4)
  buffer_load_dwordx4 v[200:203], v10, s[44:47], s8 offen nt
  s_add_u32 s8, s8, 4096
  s_waitcnt vmcnt(4)
  buffer_load_dwordx4 v[204:207], v10, s[44:47], s8 offen nt
  s_add_u32 s8, s8, 4096
  s_waitcnt vmcnt(4)
  buffer_load_dwordx4 v[208:211], v10, s[44:47], s8 offen nt
  s_add_u32 s8, s8, 4096
  s_waitcnt vmcnt(4)
  buffer_load_dwordx4 v[212:215], v10, s[44:47], s8 offen nt
  s_add_u32 s8, s8, 4096
  s_waitcnt vmcnt(4)
  buffer_load_dwordx4 v[216:219], v10, s[44:47], s8 offen nt
  s_add_u32 s8, s8, 4096
  s_waitcnt vmcnt(4)
  buffer_load_dwordx4 v[220:223], v10, s[44:47], s8 offen nt
  s_add_u32 s8, s8, 4096
  s_waitcnt vmcnt(4)
  buffer_load_dwordx4 v[224:227], v10, s[44:47], s8 offen nt
  s_add_u32 s8, s8, 4096
  s_waitcnt vmcnt(4)
  buffer_load_dwordx4 v[228:231], v10, s[44:47], s8 offen nt
  s_add_u32 s8, s8, 4096
  s_waitcnt vmcnt(4)
  buffer_load_dwordx4 v[232:235], v10, s[44:47], s8 offen nt
  s_add_u32 s8, s8, 4096
  s_waitcnt vmcnt(4)
  buffer_load_dwordx4 v[236:239], v10, s[44:47], s8 offen nt
  s_add_u32 s8, s8, 4096
  s_waitcnt vmcnt(4)
  buffer_load_dwordx4 v[240:243], v10, s[44:47], s8 offen nt
  s_add_u32 s8, s8, 4096
  s_waitcnt vmcnt(4)
  buffer_load_dwordx4 v[244:247], v10, s[44:47], s8 offen nt
  s_add_u32 s8, s8, 4096
  s_waitcnt vmcnt(4)
  buffer_load_dwordx4 v[248:251], v10, s[44:47], s8 offen nt
  s_add_u32 s8, s8, 4096
  s_waitcnt vmcnt(4)
  buffer_load_dwordx4 v[252:255], v10, s[44:47], s8 offen nt
  s_add_u32 s8, s8, 4096
  s_barrier
  ds_read_b128 v[32:35], v16 offset:0
  ds_read_b128 v[36:39], v16 offset:16
  ds_read_b128 v[40:43], v16 offset:512
  ds_read_b128 v[44:47], v16 offset:528
  ds_read_b128 v[52:55], v16 offset:1024
  ds_read_b128 v[56:59], v16 offset:1040
  ds_read_b128 v[60:63], v16 offset:1536
  ds_read_b128 v[24:27], v16 offset:1552
  s_waitcnt lgkmcnt(0)
  v_add_f32 v32, v32, v40
  v_add_f32 v52, v52, v60
  v_add_f32 v33, v33, v41
  v_add_f32 v53, v53, v61
  v_add_f32 v34, v34, v42
  v_add_f32 v54, v54, v62
  v_add_f32 v35, v35, v43
  v_add_f32 v55, v55, v63
  v_add_f32 v36, v36, v44
  v_add_f32 v56, v56, v24
  v_add_f32 v37, v37, v45
  v_add_f32 v57, v57, v25
  v_add_f32 v38, v38, v46
  v_add_f32 v58, v58, v26
  v_add_f32 v39, v39, v47
  v_add_f32 v59, v59, v27
  v_add_f32 v32, v32, v52
  v_add_f32 v33, v33, v53
  v_add_f32 v34, v34, v54
  v_add_f32 v35, v35, v55
  v_add_f32 v36, v36, v56
  v_add_f32 v37, v37, v57
  v_add_f32 v38, v38, v58
  v_add_f32 v39, v39, v59
  v_cvt_pk_bf16_f32 v12, v32, v33
  v_cvt_pk_bf16_f32 v13, v34, v35
  v_cvt_pk_bf16_f32 v14, v36, v37
  v_cvt_pk_bf16_f32 v15, v38, v39
  s_waitcnt vmcnt(47)
  v_dot2_f32_bf16 v32, v64, v12, 0
  v_dot2_f32_bf16 v32, v65, v13, v32
  v_dot2_f32_bf16 v32, v66, v14, v32
  v_dot2_f32_bf16 v32, v67, v15, v32
  s_waitcnt vmcnt(46)
  v_dot2_f32_bf16 v33, v68, v12, 0
  v_dot2_f32_bf16 v33, v69, v13, v33
  v_dot2_f32_bf16 v33, v70, v14, v33
  v_dot2_f32_bf16 v33, v71, v15, v33
  s_waitcnt vmcnt(45)
  v_dot2_f32_bf16 v34, v72, v12, 0
  v_dot2_f32_bf16 v34, v73, v13, v34
  v_dot2_f32_bf16 v34, v74, v14, v34
  v_dot2_f32_bf16 v34, v75, v15, v34
  v_add_f32_dpp v32, v32, v32 row_ror:8 row_mask:0xf bank_mask:0x3
  v_add_f32_dpp v32, v33, v33 row_ror:8 row_mask:0xf bank_mask:0xc
  s_waitcnt vmcnt(4)
  buffer_load_dwordx4 v[64:67], v10, s[44:47], s8 offen nt
  s_add_u32 s8, s8, 4096
  s_waitcnt vmcnt(45)
  v_dot2_f32_bf16 v35, v76, v12, 0
  v_dot2_f32_bf16 v35, v77, v13, v35
  v_dot2_f32_bf16 v35, v78, v14, v35
  v_dot2_f32_bf16 v35, v79, v15, v35
  s_waitcnt vmcnt(44)
  v_dot2_f32_bf16 v36, v80, v12, 0
  v_dot2_f32_bf16 v36, v81, v13, v36
  v_dot2_f32_bf16 v36, v82, v14, v36
  v_dot2_f32_bf16 v36, v83, v15, v36
  v_add_f32_dpp v34, v34, v34 row_ror:8 row_mask:0xf bank_mask:0x3
  v_add_f32_dpp v34, v35, v35 row_ror:8 row_mask:0xf bank_mask:0xc
  s_waitcnt vmcnt(43)
  v_dot2_f32_bf16 v37, v84, v12, 0
  v_dot2_f32_bf16 v37, v85, v13, v37
  v_dot2_f32_bf16 v37, v86, v14, v37
  v_dot2_f32_bf16 v37, v87, v15, v37
  v_add_f32_dpp v32, v32, v32 row_half_mirror row_mask:0xf bank_mask:0x5
  v_add_f32_dpp v32, v34, v34 row_half_mirror row_mask:0xf bank_mask:0xa
  s_waitcnt vmcnt(4)
  buffer_load_dwordx4 v[68:71], v10, s[44:47], s8 offen nt
  s_add_u32 s8, s8, 4096
  s_waitcnt vmcnt(43)
  v_dot2_f32_bf16 v38, v88, v12, 0
  v_dot2_f32_bf16 v38, v89, v13, v38
  v_dot2_f32_bf16 v38, v90, v14, v38
  v_dot2_f32_bf16 v38, v91, v15, v38
  v_add_f32_dpp v36, v36, v36 row_ror:8 row_mask:0xf bank_mask:0x3
  v_add_f32_dpp v36, v37, v37 row_ror:8 row_mask:0xf bank_mask:0xc
  s_waitcnt vmcnt(42)
  v_dot2_f32_bf16 v39, v92, v12, 0
  v_dot2_f32_bf16 v39, v93, v13, v39
  v_dot2_f32_bf16 v39, v94, v14, v39
  v_dot2_f32_bf16 v39, v95, v15, v39
  s_waitcnt vmcnt(41)
  v_dot2_f32_bf16 v40, v96, v12, 0
  v_dot2_f32_bf16 v40, v97, v13, v40
  v_dot2_f32_bf16 v40, v98, v14, v40
  v_dot2_f32_bf16 v40, v99, v15, v40
  v_add_f32_dpp v38, v38, v38 row_ror:8 row_mask:0xf bank_mask:0x3
  v_add_f32_dpp v38, v39, v39 row_ror:8 row_mask:0xf bank_mask:0xc
  s_waitcnt vmcnt(4)
  buffer_load_dwordx4 v[72:75], v10, s[44:47], s8 offen nt
  s_add_u32 s8, s8, 4096
  s_waitcnt vmcnt(41)
  v_dot2_f32_bf16 v41, v100, v12, 0
  v_dot2_f32_bf16 v41, v101, v13, v41
  v_dot2_f32_bf16 v41, v102, v14, v41
  v_dot2_f32_bf16 v41, v103, v15, v41
  v_add_f32_dpp v36, v36, v36 row_half_mirror row_mask:0xf bank_mask:0x5
  v_add_f32_dpp v36, v38, v38 row_half_mirror row_mask:0xf bank_mask:0xa
  s_waitcnt vmcnt(40)
  v_dot2_f32_bf16 v42, v104, v12, 0
  v_dot2_f32_bf16 v42, v105, v13, v42
  v_dot2_f32_bf16 v42, v106, v14, v42
  v_dot2_f32_bf16 v42, v107, v15, v42
  v_add_f32_dpp v40, v40, v40 row_ror:8 row_mask:0xf bank_mask:0x3
  v_add_f32_dpp v40, v41, v41 row_ror:8 row_mask:0xf bank_mask:0xc
  s_waitcnt vmcnt(39)
  v_dot2_f32_bf16 v43, v108, v12, 0
  v_dot2_f32_bf16 v43, v109, v13, v43
  v_dot2_f32_bf16 v43, v110, v14, v43
  v_dot2_f32_bf16 v43, v111, v15, v43
  v_cndmask_b32 v16, v36, v32, s[10:11]
  v_cndmask_b32 v17, v32, v36, s[10:11]
  s_nop 1
  v_add_f32_dpp v32, v16, v17 quad_perm:[1,0,3,2] row_mask:0xf bank_mask:0xf
  s_waitcnt vmcnt(4)
  buffer_load_dwordx4 v[76:79], v10, s[44:47], s8 offen nt
  s_add_u32 s8, s8, 4096
  s_waitcnt vmcnt(39)
  v_dot2_f32_bf16 v44, v112, v12, 0
  v_dot2_f32_bf16 v44, v113, v13, v44
  v_dot2_f32_bf16 v44, v114, v14, v44
  v_dot2_f32_bf16 v44, v115, v15, v44
  v_add_f32_dpp v42, v42, v42 row_ror:8 row_mask:0xf bank_mask:0x3
  v_add_f32_dpp v42, v43, v43 row_ror:8 row_mask:0xf bank_mask:0xc
  s_waitcnt vmcnt(38)
  v_dot2_f32_bf16 v45, v116, v12, 0
  v_dot2_f32_bf16 v45, v117, v13, v45
  v_dot2_f32_bf16 v45, v118, v14, v45
  v_dot2_f32_bf16 v45, v119, v15, v45
  v_add_f32_dpp v40, v40, v40 row_half_mirror row_mask:0xf bank_mask:0x5
  v_add_f32_dpp v40, v42, v42 row_half_mirror row_mask:0xf bank_mask:0xa
  s_waitcnt vmcnt(37)
  v_dot2_f32_bf16 v46, v120, v12, 0
  v_dot2_f32_bf16 v46, v121, v13, v46
  v_dot2_f32_bf16 v46, v122, v14, v46
  v_dot2_f32_bf16 v46, v123, v15, v46
  v_add_f32_dpp v44, v44, v44 row_ror:8 row_mask:0xf bank_mask:0x3
  v_add_f32_dpp v44, v45, v45 row_ror:8 row_mask:0xf bank_mask:0xc
  s_waitcnt vmcnt(4)
  buffer_load_dwordx4 v[80:83], v10, s[44:47], s8 offen nt
  s_add_u32 s8, s8, 4096
  s_waitcnt vmcnt(37)
  v_dot2_f32_bf16 v47, v124, v12, 0
  v_dot2_f32_bf16 v47, v125, v13, v47
  v_dot2_f32_bf16 v47, v126, v14, v47
  v_dot2_f32_bf16 v47, v127, v15, v47
  s_nop 2
  v_add_f32_dpp v46, v46, v46 row_ror:8 row_mask:0xf bank_mask:0x3
  v_add_f32_dpp v46, v47, v47 row_ror:8 row_mask:0xf bank_mask:0xc
  s_nop 1
  v_add_f32_dpp v44, v44, v44 row_half_mirror row_mask:0xf bank_mask:0x5
  v_add_f32_dpp v44, v46, v46 row_half_mirror row_mask:0xf bank_mask:0xa
  s_nop 0
  v_cndmask_b32 v16, v44, v40, s[10:11]
  v_cndmask_b32 v17, v40, v44, s[10:11]
  s_nop 1
  v_add_f32_dpp v40, v16, v17 quad_perm:[1,0,3,2] row_mask:0xf bank_mask:0xf
  s_nop 0
  v_cndmask_b32 v16, v40, v32, s[12:13]
  v_cndmask_b32 v17, v32, v40, s[12:13]
  s_nop 1
  v_add_f32_dpp v32, v16, v17 quad_perm:[2,3,0,1] row_mask:0xf bank_mask:0xf
  v_cvt_pk_bf16_f32 v32, v32, v32
  v_and_b32 v32, 0xffff0000, v32
  v_mul_f32 v32, s14, v32
  v_cvt_pk_bf16_f32 v32, v32, v32
  v_and_b32 v32, 0xffff0000, v32
  ds_write_b32 v20, v32
  v_add_u32 v20, 256, v20
  v_max_f32 v16, v18, v32
  v_sub_f32 v17, v18, v16
  v_sub_f32 v32, v32, v16
  v_mul_f32 v17, s15, v17
  v_mul_f32 v32, s15, v32
  v_exp_f32 v17, v17
  v_exp_f32 v32, v32
  v_mov_b32 v18, v16
  v_fma_f32 v19, v19, v17, v32
  s_waitcnt vmcnt(36)
  v_dot2_f32_bf16 v32, v128, v12, 0
  v_dot2_f32_bf16 v32, v129, v13, v32
  v_dot2_f32_bf16 v32, v130, v14, v32
  v_dot2_f32_bf16 v32, v131, v15, v32
  s_waitcnt vmcnt(35)
  v_dot2_f32_bf16 v33, v132, v12, 0
  v_dot2_f32_bf16 v33, v133, v13, v33
  v_dot2_f32_bf16 v33, v134, v14, v33
  v_dot2_f32_bf16 v33, v135, v15, v33
  s_waitcnt vmcnt(4)
  buffer_load_dwordx4 v[84:87], v10, s[44:47], s8 offen nt
  s_add_u32 s8, s8, 4096
  s_waitcnt vmcnt(35)
  v_dot2_f32_bf16 v34, v136, v12, 0
  v_dot2_f32_bf16 v34, v137, v13, v34
  v_dot2_f32_bf16 v34, v138, v14, v34
  v_dot2_f32_bf16 v34, v139, v15, v34
  v_add_f32_dpp v32, v32, v32 row_ror:8 row_mask:0xf bank_mask:0x3
  v_add_f32_dpp v32, v33, v33 row_ror:8 row_mask:0xf bank_mask:0xc
  s_waitcnt vmcnt(34)
  v_dot2_f32_bf16 v35, v140, v12, 0
  v_dot2_f32_bf16 v35, v141, v13, v35
  v_dot2_f32_bf16 v35, v142, v14, v35
  v_dot2_f32_bf16 v35, v143, v15, v35
  s_waitcnt vmcnt(33)
  v_dot2_f32_bf16 v36, v144, v12, 0
  v_dot2_f32_bf16 v36, v145, v13, v36
  v_dot2_f32_bf16 v36, v146, v14, v36
  v_dot2_f32_bf16 v36, v147, v15, v36
  v_add_f32_dpp v34, v34, v34 row_ror:8 row_mask:0xf bank_mask:0x3
  v_add_f32_dpp v34, v35, v35 row_ror:8 row_mask:0xf bank_mask:0xc
  s_waitcnt vmcnt(4)
  buffer_load_dwordx4 v[88:91], v10, s[44:47], s8 offen nt
  s_add_u32 s8, s8, 4096
  s_waitcnt vmcnt(33)
  v_dot2_f32_bf16 v37, v148, v12, 0
  v_dot2_f32_bf16 v37, v149, v13, v37
  v_dot2_f32_bf16 v37, v150, v14, v37
  v_dot2_f32_bf16 v37, v151, v15, v37
  v_add_f32_dpp v32, v32, v32 row_half_mirror row_mask:0xf bank_mask:0x5
  v_add_f32_dpp v32, v34, v34 row_half_mirror row_mask:0xf bank_mask:0xa
  s_waitcnt vmcnt(32)
  v_dot2_f32_bf16 v38, v152, v12, 0
  v_dot2_f32_bf16 v38, v153, v13, v38
  v_dot2_f32_bf16 v38, v154, v14, v38
  v_dot2_f32_bf16 v38, v155, v15, v38
  v_add_f32_dpp v36, v36, v36 row_ror:8 row_mask:0xf bank_mask:0x3
  v_add_f32_dpp v36, v37, v37 row_ror:8 row_mask:0xf bank_mask:0xc
  s_waitcnt vmcnt(31)
  v_dot2_f32_bf16 v39, v156, v12, 0
  v_dot2_f32_bf16 v39, v157, v13, v39
  v_dot2_f32_bf16 v39, v158, v14, v39
  v_dot2_f32_bf16 v39, v159, v15, v39
  s_waitcnt vmcnt(4)
  buffer_load_dwordx4 v[92:95], v10, s[44:47], s8 offen nt
  s_add_u32 s8, s8, 4096
  s_waitcnt vmcnt(31)
  v_dot2_f32_bf16 v40, v160, v12, 0
  v_dot2_f32_bf16 v40, v161, v13, v40
  v_dot2_f32_bf16 v40, v162, v14, v40
  v_dot2_f32_bf16 v40, v163, v15, v40
  v_add_f32_dpp v38, v38, v38 row_ror:8 row_mask:0xf bank_mask:0x3
  v_add_f32_dpp v38, v39, v39 row_ror:8 row_mask:0xf bank_mask:0xc
  s_waitcnt vmcnt(30)
  v_dot2_f32_bf16 v41, v164, v12, 0
  v_dot2_f32_bf16 v41, v165, v13, v41
  v_dot2_f32_bf16 v41, v166, v14, v41
  v_dot2_f32_bf16 v41, v167, v15, v41
  v_add_f32_dpp v36, v36, v36 row_half_mirror row_mask:0xf bank_mask:0x5
  v_add_f32_dpp v36, v38, v38 row_half_mirror row_mask:0xf bank_mask:0xa
  s_waitcnt vmcnt(29)
  v_dot2_f32_bf16 v42, v168, v12, 0
  v_dot2_f32_bf16 v42, v169, v13, v42
  v_dot2_f32_bf16 v42, v170, v14, v42
  v_dot2_f32_bf16 v42, v171, v15, v42
  v_add_f32_dpp v40, v40, v40 row_ror:8 row_mask:0xf bank_mask:0x3
  v_add_f32_dpp v40, v41, v41 row_ror:8 row_mask:0xf bank_mask:0xc
  s_waitcnt vmcnt(4)
  buffer_load_dwordx4 v[96:99], v10, s[44:47], s8 offen nt
  s_add_u32 s8, s8, 4096
  s_waitcnt vmcnt(29)
  v_dot2_f32_bf16 v43, v172, v12, 0
  v_dot2_f32_bf16 v43, v173, v13, v43
  v_dot2_f32_bf16 v43, v174, v14, v43
  v_dot2_f32_bf16 v43, v175, v15, v43
  v_cndmask_b32 v16, v36, v32, s[10:11]
  v_cndmask_b32 v17, v32, v36, s[10:11]
  s_nop 1
  v_add_f32_dpp v32, v16, v17 quad_perm:[1,0,3,2] row_mask:0xf bank_mask:0xf
  s_waitcnt vmcnt(28)
  v_dot2_f32_bf16 v44, v176, v12, 0
  v_dot2_f32_bf16 v44, v177, v13, v44
  v_dot2_f32_bf16 v44, v178, v14, v44
  v_dot2_f32_bf16 v44, v179, v15, v44
  v_add_f32_dpp v42, v42, v42 row_ror:8 row_mask:0xf bank_mask:0x3
  v_add_f32_dpp v42, v43, v43 row_ror:8 row_mask:0xf bank_mask:0xc
  s_waitcnt vmcnt(27)
  v_dot2_f32_bf16 v45, v180, v12, 0
  v_dot2_f32_bf16 v45, v181, v13, v45
  v_dot2_f32_bf16 v45, v182, v14, v45
  v_dot2_f32_bf16 v45, v183, v15, v45
  v_add_f32_dpp v40, v40, v40 row_half_mirror row_mask:0xf bank_mask:0x5
  v_add_f32_dpp v40, v42, v42 row_half_mirror row_mask:0xf bank_mask:0xa
  s_waitcnt vmcnt(4)
  buffer_load_dwordx4 v[100:103], v10, s[44:47], s8 offen nt
  s_add_u32 s8, s8, 4096
  s_waitcnt vmcnt(27)
  v_dot2_f32_bf16 v46, v184, v12, 0
  v_dot2_f32_bf16 v46, v185, v13, v46
  v_dot2_f32_bf16 v46, v186, v14, v46
  v_dot2_f32_bf16 v46, v187, v15, v46
  v_add_f32_dpp v44, v44, v44 row_ror:8 row_mask:0xf bank_mask:0x3
  v_add_f32_dpp v44, v45, v45 row_ror:8 row_mask:0xf bank_mask:0xc
  s_waitcnt vmcnt(26)
  v_dot2_f32_bf16 v47, v188, v12, 0
  v_dot2_f32_bf16 v47, v189, v13, v47
  v_dot2_f32_bf16 v47, v190, v14, v47
  v_dot2_f32_bf16 v47, v191, v15, v47
  s_nop 2
  v_add_f32_dpp v46, v46, v46 row_ror:8 row_mask:0xf bank_mask:0x3
  v_add_f32_dpp v46, v47, v47 row_ror:8 row_mask:0xf bank_mask:0xc
  s_nop 1
  v_add_f32_dpp v44, v44, v44 row_half_mirror row_mask:0xf bank_mask:0x5
  v_add_f32_dpp v44, v46, v46 row_half_mirror row_mask:0xf bank_mask:0xa
  s_nop 0
  v_cndmask_b32 v16, v44, v40, s[10:11]
  v_cndmask_b32 v17, v40, v44, s[10:11]
  s_nop 1
  v_add_f32_dpp v40, v16, v17 quad_perm:[1,0,3,2] row_mask:0xf bank_mask:0xf
  s_nop 0
  v_cndmask_b32 v16, v40, v32, s[12:13]
  v_cndmask_b32 v17, v32, v40, s[12:13]
  s_nop 1
  v_add_f32_dpp v32, v16, v17 quad_perm:[2,3,0,1] row_mask:0xf bank_mask:0xf
  v_cvt_pk_bf16_f32 v32, v32, v32
  v_and_b32 v32, 0xffff0000, v32
  v_mul_f32 v32, s14, v32
  v_cvt_pk_bf16_f32 v32, v32, v32
  v_and_b32 v32, 0xffff0000, v32
  ds_write_b32 v20, v32
  v_add_u32 v20, 256, v20
  v_max_f32 v16, v18, v32
  v_sub_f32 v17, v18, v16
  v_sub_f32 v32, v32, v16
  v_mul_f32 v17, s15, v17
  v_mul_f32 v32, s15, v32
  v_exp_f32 v17, v17
  v_exp_f32 v32, v32
  v_mov_b32 v18, v16
  v_fma_f32 v19, v19, v17, v32
  s_waitcnt vmcnt(25)
  v_dot2_f32_bf16 v32, v192, v12, 0
  v_dot2_f32_bf16 v32, v193, v13, v32
  v_dot2_f32_bf16 v32, v194, v14, v32
  v_dot2_f32_bf16 v32, v195, v15, v32
  s_waitcnt vmcnt(4)
  buffer_load_dwordx4 v[104:107], v10, s[44:47], s8 offen nt
  s_add_u32 s8, s8, 4096
  s_waitcnt vmcnt(25)
  v_dot2_f32_bf16 v33, v196, v12, 0
  v_dot2_f32_bf16 v33, v197, v13, v33
  v_dot2_f32_bf16 v33, v198, v14, v33
  v_dot2_f32_bf16 v33, v199, v15, v33
  s_waitcnt vmcnt(24)
  v_dot2_f32_bf16 v34, v200, v12, 0
  v_dot2_f32_bf16 v34, v201, v13, v34
  v_dot2_f32_bf16 v34, v202, v14, v34
  v_dot2_f32_bf16 v34, v203, v15, v34
  v_add_f32_dpp v32, v32, v32 row_ror:8 row_mask:0xf bank_mask:0x3
  v_add_f32_dpp v32, v33, v33 row_ror:8 row_mask:0xf bank_mask:0xc
  s_waitcnt vmcnt(23)
  v_dot2_f32_bf16 v35, v204, v12, 0
  v_dot2_f32_bf16 v35, v205, v13, v35
  v_dot2_f32_bf16 v35, v206, v14, v35
  v_dot2_f32_bf16 v35, v207, v15, v35
  s_waitcnt vmcnt(4)
  buffer_load_dwordx4 v[108:111], v10, s[44:47], s8 offen nt
  s_add_u32 s8, s8, 4096
  s_waitcnt vmcnt(23)
  v_dot2_f32_bf16 v36, v208, v12, 0
  v_dot2_f32_bf16 v36, v209, v13, v36
  v_dot2_f32_bf16 v36, v210, v14, v36
  v_dot2_f32_bf16 v36, v211, v15, v36
  v_add_f32_dpp v34, v34, v34 row_ror:8 row_mask:0xf bank_mask:0x3
  v_add_f32_dpp v34, v35, v35 row_ror:8 row_mask:0xf bank_mask:0xc
  s_waitcnt vmcnt(22)
  v_dot2_f32_bf16 v37, v212, v12, 0
  v_dot2_f32_bf16 v37, v213, v13, v37
  v_dot2_f32_bf16 v37, v214, v14, v37
  v_dot2_f32_bf16 v37, v215, v15, v37
  v_add_f32_dpp v32, v32, v32 row_half_mirror row_mask:0xf bank_mask:0x5
  v_add_f32_dpp v32, v34, v34 row_half_mirror row_mask:0xf bank_mask:0xa
  s_waitcnt vmcnt(21)
  v_dot2_f32_bf16 v38, v216, v12, 0
  v_dot2_f32_bf16 v38, v217, v13, v38
  v_dot2_f32_bf16 v38, v218, v14, v38
  v_dot2_f32_bf16 v38, v219, v15, v38
  v_add_f32_dpp v36, v36, v36 row_ror:8 row_mask:0xf bank_mask:0x3
  v_add_f32_dpp v36, v37, v37 row_ror:8 row_mask:0xf bank_mask:0xc
  s_waitcnt vmcnt(4)
  buffer_load_dwordx4 v[112:115], v10, s[44:47], s8 offen nt
  s_add_u32 s8, s8, 4096
  s_waitcnt vmcnt(21)
  v_dot2_f32_bf16 v39, v220, v12, 0
  v_dot2_f32_bf16 v39, v221, v13, v39
  v_dot2_f32_bf16 v39, v222, v14, v39
  v_dot2_f32_bf16 v39, v223, v15, v39
  s_waitcnt vmcnt(20)
  v_dot2_f32_bf16 v40, v224, v12, 0
  v_dot2_f32_bf16 v40, v225, v13, v40
  v_dot2_f32_bf16 v40, v226, v14, v40
  v_dot2_f32_bf16 v40, v227, v15, v40
  v_add_f32_dpp v38, v38, v38 row_ror:8 row_mask:0xf bank_mask:0x3
  v_add_f32_dpp v38, v39, v39 row_ror:8 row_mask:0xf bank_mask:0xc
  s_waitcnt vmcnt(19)
  v_dot2_f32_bf16 v41, v228, v12, 0
  v_dot2_f32_bf16 v41, v229, v13, v41
  v_dot2_f32_bf16 v41, v230, v14, v41
  v_dot2_f32_bf16 v41, v231, v15, v41
  v_add_f32_dpp v36, v36, v36 row_half_mirror row_mask:0xf bank_mask:0x5
  v_add_f32_dpp v36, v38, v38 row_half_mirror row_mask:0xf bank_mask:0xa
  s_waitcnt vmcnt(4)
  buffer_load_dwordx4 v[116:119], v10, s[44:47], s8 offen nt
  s_add_u32 s8, s8, 4096
  s_waitcnt vmcnt(19)
  v_dot2_f32_bf16 v42, v232, v12, 0
  v_dot2_f32_bf16 v42, v233, v13, v42
  v_dot2_f32_bf16 v42, v234, v14, v42
  v_dot2_f32_bf16 v42, v235, v15, v42
  v_add_f32_dpp v40, v40, v40 row_ror:8 row_mask:0xf bank_mask:0x3
  v_add_f32_dpp v40, v41, v41 row_ror:8 row_mask:0xf bank_mask:0xc
  s_waitcnt vmcnt(18)
  v_dot2_f32_bf16 v43, v236, v12, 0
  v_dot2_f32_bf16 v43, v237, v13, v43
  v_dot2_f32_bf16 v43, v238, v14, v43
  v_dot2_f32_bf16 v43, v239, v15, v43
  v_cndmask_b32 v16, v36, v32, s[10:11]
  v_cndmask_b32 v17, v32, v36, s[10:11]
  s_nop 1
  v_add_f32_dpp v32, v16, v17 quad_perm:[1,0,3,2] row_mask:0xf bank_mask:0xf
  s_waitcnt vmcnt(17)
  v_dot2_f32_bf16 v44, v240, v12, 0
  v_dot2_f32_bf16 v44, v241, v13, v44
  v_dot2_f32_bf16 v44, v242, v14, v44
  v_dot2_f32_bf16 v44, v243, v15, v44
  v_add_f32_dpp v42, v42, v42 row_ror:8 row_mask:0xf bank_mask:0x3
  v_add_f32_dpp v42, v43, v43 row_ror:8 row_mask:0xf bank_mask:0xc
  s_waitcnt vmcnt(4)
  buffer_load_dwordx4 v[120:123], v10, s[44:47], s8 offen nt
  s_add_u32 s8, s8, 4096
  s_waitcnt vmcnt(17)
  v_dot2_f32_bf16 v45, v244, v12, 0
  v_dot2_f32_bf16 v45, v245, v13, v45
  v_dot2_f32_bf16 v45, v246, v14, v45
  v_dot2_f32_bf16 v45, v247, v15, v45
  v_add_f32_dpp v40, v40, v40 row_half_mirror row_mask:0xf bank_mask:0x5
  v_add_f32_dpp v40, v42, v42 row_half_mirror row_mask:0xf bank_mask:0xa
  s_waitcnt vmcnt(16)
  v_dot2_f32_bf16 v46, v248, v12, 0
  v_dot2_f32_bf16 v46, v249, v13, v46
  v_dot2_f32_bf16 v46, v250, v14, v46
  v_dot2_f32_bf16 v46, v251, v15, v46
  v_add_f32_dpp v44, v44, v44 row_ror:8 row_mask:0xf bank_mask:0x3
  v_add_f32_dpp v44, v45, v45 row_ror:8 row_mask:0xf bank_mask:0xc
  s_waitcnt vmcnt(15)
  v_dot2_f32_bf16 v47, v252, v12, 0
  v_dot2_f32_bf16 v47, v253, v13, v47
  v_dot2_f32_bf16 v47, v254, v14, v47
  v_dot2_f32_bf16 v47, v255, v15, v47
  s_nop 2
  v_add_f32_dpp v46, v46, v46 row_ror:8 row_mask:0xf bank_mask:0x3
  v_add_f32_dpp v46, v47, v47 row_ror:8 row_mask:0xf bank_mask:0xc
  s_nop 1
  v_add_f32_dpp v44, v44, v44 row_half_mirror row_mask:0xf bank_mask:0x5
  v_add_f32_dpp v44, v46, v46 row_half_mirror row_mask:0xf bank_mask:0xa
  s_nop 0
  v_cndmask_b32 v16, v44, v40, s[10:11]
  v_cndmask_b32 v17, v40, v44, s[10:11]
  s_nop 1
  v_add_f32_dpp v40, v16, v17 quad_perm:[1,0,3,2] row_mask:0xf bank_mask:0xf
  s_nop 0
  v_cndmask_b32 v16, v40, v32, s[12:13]
  v_cndmask_b32 v17, v32, v40, s[12:13]
  s_nop 1
  v_add_f32_dpp v32, v16, v17 quad_perm:[2,3,0,1] row_mask:0xf bank_mask:0xf
  v_cvt_pk_bf16_f32 v32, v32, v32
  v_and_b32 v32, 0xffff0000, v32
  v_mul_f32 v32, s14, v32
  v_cvt_pk_bf16_f32 v32, v32, v32
  v_and_b32 v32, 0xffff0000, v32
  ds_write_b32 v20, v32
  v_add_u32 v20, 256, v20
  v_max_f32 v16, v18, v32
  v_sub_f32 v17, v18, v16
  v_sub_f32 v32, v32, v16
  v_mul_f32 v17, s15, v17
  v_mul_f32 v32, s15, v32
  v_exp_f32 v17, v17
  v_exp_f32 v32, v32
  v_mov_b32 v18, v16
  v_fma_f32 v19, v19, v17, v32
  s_waitcnt vmcnt(4)
  buffer_load_dwordx4 v[124:127], v10, s[44:47], s8 offen nt
  s_add_u32 s8, s8, 4096
  s_waitcnt vmcnt(15)
  v_dot2_f32_bf16 v32, v64, v12, 0
  v_dot2_f32_bf16 v32, v65, v13, v32
  v_dot2_f32_bf16 v32, v66, v14, v32
  v_dot2_f32_bf16 v32, v67, v15, v32
  s_waitcnt vmcnt(14)
  v_dot2_f32_bf16 v33, v68, v12, 0
  v_dot2_f32_bf16 v33, v69, v13, v33
  v_dot2_f32_bf16 v33, v70, v14, v33
  v_dot2_f32_bf16 v33, v71, v15, v33
  s_waitcnt vmcnt(13)
  v_dot2_f32_bf16 v34, v72, v12, 0
  v_dot2_f32_bf16 v34, v73, v13, v34
  v_dot2_f32_bf16 v34, v74, v14, v34
  v_dot2_f32_bf16 v34, v75, v15, v34
  v_add_f32_dpp v32, v32, v32 row_ror:8 row_mask:0xf bank_mask:0x3
  v_add_f32_dpp v32, v33, v33 row_ror:8 row_mask:0xf bank_mask:0xc
  s_waitcnt vmcnt(4)
  buffer_load_dwordx4 v[64:67], v10, s[44:47], s8 offen nt
  s_add_u32 s8, s8, 4096
  s_waitcnt vmcnt(13)
  v_dot2_f32_bf16 v35, v76, v12, 0
  v_dot2_f32_bf16 v35, v77, v13, v35
  v_dot2_f32_bf16 v35, v78, v14, v35
  v_dot2_f32_bf16 v35, v79, v15, v35
  s_waitcnt vmcnt(12)
  v_dot2_f32_bf16 v36, v80, v12, 0
  v_dot2_f32_bf16 v36, v81, v13, v36
  v_dot2_f32_bf16 v36, v82, v14, v36
  v_dot2_f32_bf16 v36, v83, v15, v36
  v_add_f32_dpp v34, v34, v34 row_ror:8 row_mask:0xf bank_mask:0x3
  v_add_f32_dpp v34, v35, v35 row_ror:8 row_mask:0xf bank_mask:0xc
  s_waitcnt vmcnt(4)
  buffer_load_dwordx4 v[68:71], v10, s[44:47], s8 offen nt
  s_add_u32 s8, s8, 4096
  s_waitcnt vmcnt(12)
  v_dot2_f32_bf16 v37, v84, v12, 0
  v_dot2_f32_bf16 v37, v85, v13, v37
  v_dot2_f32_bf16 v37, v86, v14, v37
  v_dot2_f32_bf16 v37, v87, v15, v37
  v_add_f32_dpp v32, v32, v32 row_half_mirror row_mask:0xf bank_mask:0x5
  v_add_f32_dpp v32, v34, v34 row_half_mirror row_mask:0xf bank_mask:0xa
  s_waitcnt vmcnt(11)
  v_dot2_f32_bf16 v38, v88, v12, 0
  v_dot2_f32_bf16 v38, v89, v13, v38
  v_dot2_f32_bf16 v38, v90, v14, v38
  v_dot2_f32_bf16 v38, v91, v15, v38
  v_add_f32_dpp v36, v36, v36 row_ror:8 row_mask:0xf bank_mask:0x3
  v_add_f32_dpp v36, v37, v37 row_ror:8 row_mask:0xf bank_mask:0xc
  s_waitcnt vmcnt(4)
  buffer_load_dwordx4 v[72:75], v10, s[44:47], s8 offen nt
  s_add_u32 s8, s8, 4096
  s_waitcnt vmcnt(11)
  v_dot2_f32_bf16 v39, v92, v12, 0
  v_dot2_f32_bf16 v39, v93, v13, v39
  v_dot2_f32_bf16 v39, v94, v14, v39
  v_dot2_f32_bf16 v39, v95, v15, v39
  s_waitcnt vmcnt(10)
  v_dot2_f32_bf16 v40, v96, v12, 0
  v_dot2_f32_bf16 v40, v97, v13, v40
  v_dot2_f32_bf16 v40, v98, v14, v40
  v_dot2_f32_bf16 v40, v99, v15, v40
  v_add_f32_dpp v38, v38, v38 row_ror:8 row_mask:0xf bank_mask:0x3
  v_add_f32_dpp v38, v39, v39 row_ror:8 row_mask:0xf bank_mask:0xc
  s_waitcnt vmcnt(9)
  v_dot2_f32_bf16 v41, v100, v12, 0
  v_dot2_f32_bf16 v41, v101, v13, v41
  v_dot2_f32_bf16 v41, v102, v14, v41
  v_dot2_f32_bf16 v41, v103, v15, v41
  v_add_f32_dpp v36, v36, v36 row_half_mirror row_mask:0xf bank_mask:0x5
  v_add_f32_dpp v36, v38, v38 row_half_mirror row_mask:0xf bank_mask:0xa
  s_waitcnt vmcnt(4)
  buffer_load_dwordx4 v[76:79], v10, s[44:47], s8 offen nt
  s_add_u32 s8, s8, 4096
  s_waitcnt vmcnt(9)
  v_dot2_f32_bf16 v42, v104, v12, 0
  v_dot2_f32_bf16 v42, v105, v13, v42
  v_dot2_f32_bf16 v42, v106, v14, v42
  v_dot2_f32_bf16 v42, v107, v15, v42
  v_add_f32_dpp v40, v40, v40 row_ror:8 row_mask:0xf bank_mask:0x3
  v_add_f32_dpp v40, v41, v41 row_ror:8 row_mask:0xf bank_mask:0xc
  s_waitcnt vmcnt(8)
  v_dot2_f32_bf16 v43, v108, v12, 0
  v_dot2_f32_bf16 v43, v109, v13, v43
  v_dot2_f32_bf16 v43, v110, v14, v43
  v_dot2_f32_bf16 v43, v111, v15, v43
  v_cndmask_b32 v16, v36, v32, s[10:11]
  v_cndmask_b32 v17, v32, v36, s[10:11]
  s_nop 1
  v_add_f32_dpp v32, v16, v17 quad_perm:[1,0,3,2] row_mask:0xf bank_mask:0xf
  s_waitcnt vmcnt(4)
  buffer_load_dwordx4 v[80:83], v10, s[44:47], s8 offen nt
  s_add_u32 s8, s8, 4096
  s_waitcnt vmcnt(8)
  v_dot2_f32_bf16 v44, v112, v12, 0
  v_dot2_f32_bf16 v44, v113, v13, v44
  v_dot2_f32_bf16 v44, v114, v14, v44
  v_dot2_f32_bf16 v44, v115, v15, v44
  v_add_f32_dpp v42, v42, v42 row_ror:8 row_mask:0xf bank_mask:0x3
  v_add_f32_dpp v42, v43, v43 row_ror:8 row_mask:0xf bank_mask:0xc
  s_waitcnt vmcnt(7)
  v_dot2_f32_bf16 v45, v116, v12, 0
  v_dot2_f32_bf16 v45, v117, v13, v45
  v_dot2_f32_bf16 v45, v118, v14, v45
  v_dot2_f32_bf16 v45, v119, v15, v45
  v_add_f32_dpp v40, v40, v40 row_half_mirror row_mask:0xf bank_mask:0x5
  v_add_f32_dpp v40, v42, v42 row_half_mirror row_mask:0xf bank_mask:0xa
  s_waitcnt vmcnt(4)
  buffer_load_dwordx4 v[84:87], v10, s[44:47], s8 offen nt
  s_add_u32 s8, s8, 4096
  s_waitcnt vmcnt(7)
  v_dot2_f32_bf16 v46, v120, v12, 0
  v_dot2_f32_bf16 v46, v121, v13, v46
  v_dot2_f32_bf16 v46, v122, v14, v46
  v_dot2_f32_bf16 v46, v123, v15, v46
  v_add_f32_dpp v44, v44, v44 row_ror:8 row_mask:0xf bank_mask:0x3
  v_add_f32_dpp v44, v45, v45 row_ror:8 row_mask:0xf bank_mask:0xc
  s_waitcnt vmcnt(6)
  v_dot2_f32_bf16 v47, v124, v12, 0
  v_dot2_f32_bf16 v47, v125, v13, v47
  v_dot2_f32_bf16 v47, v126, v14, v47
  v_dot2_f32_bf16 v47, v127, v15, v47
  s_nop 2
  v_add_f32_dpp v46, v46, v46 row_ror:8 row_mask:0xf bank_mask:0x3
  v_add_f32_dpp v46, v47, v47 row_ror:8 row_mask:0xf bank_mask:0xc
  s_nop 1
  v_add_f32_dpp v44, v44, v44 row_half_mirror row_mask:0xf bank_mask:0x5
  v_add_f32_dpp v44, v46, v46 row_half_mirror row_mask:0xf bank_mask:0xa
  s_nop 0
  v_cndmask_b32 v16, v44, v40, s[10:11]
  v_cndmask_b32 v17, v40, v44, s[10:11]
  s_nop 1
  v_add_f32_dpp v40, v16, v17 quad_perm:[1,0,3,2] row_mask:0xf bank_mask:0xf
  s_nop 0
  v_cndmask_b32 v16, v40, v32, s[12:13]
  v_cndmask_b32 v17, v32, v40, s[12:13]
  s_nop 1
  v_add_f32_dpp v32, v16, v17 quad_perm:[2,3,0,1] row_mask:0xf bank_mask:0xf
  v_cvt_pk_bf16_f32 v32, v32, v32
  v_and_b32 v32, 0xffff0000, v32
  v_mul_f32 v32, s14, v32
  v_cvt_pk_bf16_f32 v32, v32, v32
  v_and_b32 v32, 0xffff0000, v32
  ds_write_b32 v20, v32
  v_add_u32 v20, 256, v20
  v_max_f32 v16, v18, v32
  v_sub_f32 v17, v18, v16
  v_sub_f32 v32, v32, v16
  v_mul_f32 v17, s15, v17
  v_mul_f32 v32, s15, v32
  v_exp_f32 v17, v17
  v_exp_f32 v32, v32
  v_mov_b32 v18, v16
  v_fma_f32 v19, v19, v17, v32
  s_waitcnt vmcnt(4)
  buffer_load_dwordx4 v[88:91], v10, s[44:47], s8 offen nt
  s_add_u32 s8, s8, 4096
  s_mov_b32 s9, 27
  s_mov_b32 s42, 4
  v_mov_b32 v11, 0
  v_mov_b32 v9, 0
  s_lshl_b32 s7, s3, 2
  s_add_u32 s7, s7, 4192
  v_mov_b32 v23, s7
L_kloop:
  s_waitcnt lgkmcnt(0)
  v_readfirstlane_b32 s43, v11
  v_mov_b32 v16, s42
  ds_write_b32 v23, v16
  ds_read_b32 v11, v9 offset:4184
  s_cmp_lt_u32 s42, s43
  s_cselect_b64 vcc, -1, 0
  s_add_u32 s42, s42, 1
  s_waitcnt vmcnt(6)
  s_cbranch_vccnz L_m_1
  s_waitcnt vmcnt(4)
L_m_1:
  buffer_load_dwordx4 v[92:95], v10, s[44:47], s8 offen nt
  s_add_u32 s8, s8, 4096
  v_dot2_f32_bf16 v32, v64, v12, 0
  v_dot2_f32_bf16 v32, v65, v13, v32
  v_dot2_f32_bf16 v32, v66, v14, v32
  v_dot2_f32_bf16 v32, v67, v15, v32
  s_waitcnt vmcnt(6)
  s_cbranch_vccnz L_m_2
  s_waitcnt vmcnt(4)
L_m_2:
  buffer_load_dwordx4 v[96:99], v10, s[44:47], s8 offen nt
  s_add_u32 s8, s8, 4096
  v_dot2_f32_bf16 v33, v68, v12, 0
  v_dot2_f32_bf16 v33, v69, v13, v33
  v_dot2_f32_bf16 v33, v70, v14, v33
  v_dot2_f32_bf16 v33, v71, v15, v33
  s_waitcnt vmcnt(6)
  s_cbranch_vccnz L_m_3
  s_waitcnt vmcnt(4)
L_m_3:
  buffer_load_dwordx4 v[100:103], v10, s[44:47], s8 offen nt
  s_add_u32 s8, s8, 4096
  v_dot2_f32_bf16 v34, v72, v12, 0
  v_dot2_f32_bf16 v34, v73, v13, v34
  v_dot2_f32_bf16 v34, v74, v14, v34
  v_dot2_f32_bf16 v34, v75, v15, v34
  v_add_f32_dpp v32, v32, v32 row_ror:8 row_mask:0xf bank_mask:0x3
  v_add_f32_dpp v32, v33, v33 row_ror:8 row_mask:0xf bank_mask:0xc
  s_waitcnt vmcnt(6)
  s_cbranch_vccnz L_m_4
  s_waitcnt vmcnt(4)
L_m_4:
  buffer_load_dwordx4 v[104:107], v10, s[44:47], s8 offen nt
  s_add_u32 s8, s8, 4096
  v_dot2_f32_bf16 v35, v76, v12, 0
  v_dot2_f32_bf16 v35, v77, v13, v35
  v_dot2_f32_bf16 v35, v78, v14, v35
  v_dot2_f32_bf16 v35, v79, v15, v35
  s_waitcnt vmcnt(6)
  s_cbranch_vccnz L_m_5
  s_waitcnt vmcnt(4)
L_m_5:
  buffer_load_dwordx4 v[108:111], v10, s[44:47], s8 offen nt
  s_add_u32 s8, s8, 4096
  v_dot2_f32_bf16 v36, v80, v12, 0
  v_dot2_f32_bf16 v36, v81, v13, v36
  v_dot2_f32_bf16 v36, v82, v14, v36
  v_dot2_f32_bf16 v36, v83, v15, v36
  v_add_f32_dpp v34, v34, v34 row_ror:8 row_mask:0xf bank_mask:0x3
  v_add_f32_dpp v34, v35, v35 row_ror:8 row_mask:0xf bank_mask:0xc
  s_waitcnt vmcnt(6)
  s_cbranch_vccnz L_m_6
  s_waitcnt vmcnt(4)
L_m_6:
  buffer_load_dwordx4 v[112:115], v10, s[44:47], s8 offen nt
  s_add_u32 s8, s8, 4096
  v_dot2_f32_bf16 v37, v84, v12, 0
  v_dot2_f32_bf16 v37, v85, v13, v37
  v_dot2_f32_bf16 v37, v86, v14, v37
  v_dot2_f32_bf16 v37, v87, v15, v37
  v_add_f32_dpp v32, v32, v32 row_half_mirror row_mask:0xf bank_mask:0x5
  v_add_f32_dpp v32, v34, v34 row_half_mirror row_mask:0xf bank_mask:0xa
  s_waitcnt vmcnt(6)
  s_cbranch_vccnz L_m_7
  s_waitcnt vmcnt(4)
L_m_7:
  buffer_load_dwordx4 v[116:119], v10, s[44:47], s8 offen nt
  s_add_u32 s8, s8, 4096
  v_dot2_f32_bf16 v38, v88, v12, 0
  v_dot2_f32_bf16 v38, v89, v13, v38
  v_dot2_f32_bf16 v38, v90, v14, v38
  v_dot2_f32_bf16 v38, v91, v15, v38
  v_add_f32_dpp v36, v36, v36 row_ror:8 row_mask:0xf bank_mask:0x3
  v_add_f32_dpp v36, v37, v37 row_ror:8 row_mask:0xf bank_mask:0xc
  s_waitcnt vmcnt(6)
  s_cbranch_vccnz L_m_8
  s_waitcnt vmcnt(4)
L_m_8:
  buffer_load_dwordx4 v[120:123], v10, s[44:47], s8 offen nt
  s_add_u32 s8, s8, 4096
  v_dot2_f32_bf16 v39, v92, v12, 0
  v_dot2_f32_bf16 v39, v93, v13, v39
  v_dot2_f32_bf16 v39, v94, v14, v39
  v_dot2_f32_bf16 v39, v95, v15, v39
  s_waitcnt vmcnt(6)
  s_cbranch_vccnz L_m_9
  s_waitcnt vmcnt(4)
L_m_9:
  buffer_load_dwordx4 v[124:127], v10, s[44:47], s8 offen nt
  s_add_u32 s8, s8, 4096
  v_dot2_f32_bf16 v40, v96, v12, 0
  v_dot2_f32_bf16 v40, v97, v13, v40
  v_dot2_f32_bf16 v40, v98, v14, v40
  v_dot2_f32_bf16 v40, v99, v15, v40
  v_add_f32_dpp v38, v38, v38 row_ror:8 row_mask:0xf bank_mask:0x3
  v_add_f32_dpp v38, v39, v39 row_ror:8 row_mask:0xf bank_mask:0xc
  s_waitcnt vmcnt(6)
  s_cbranch_vccnz L_m_10
  s_waitcnt vmcnt(4)
L_m_10:
  buffer_load_dwordx4 v[64:67], v10, s[44:47], s8 offen nt
  s_add_u32 s8, s8, 4096
  v_dot2_f32_bf16 v41, v100, v12, 0
  v_dot2_f32_bf16 v41, v101, v13, v41
  v_dot2_f32_bf16 v41, v102, v14, v41
  v_dot2_f32_bf16 v41, v103, v15, v41
  v_add_f32_dpp v36, v36, v36 row_half_mirror row_mask:0xf bank_mask:0x5
  v_add_f32_dpp v36, v38, v38 row_half_mirror row_mask:0xf bank_mask:0xa
  s_waitcnt vmcnt(6)
  s_cbranch_vccnz L_m_11
  s_waitcnt vmcnt(4)
L_m_11:
  buffer_load_dwordx4 v[68:71], v10, s[44:47], s8 offen nt
  s_add_u32 s8, s8, 4096
  v_dot2_f32_bf16 v42, v104, v12, 0
  v_dot2_f32_bf16 v42, v105, v13, v42
  v_dot2_f32_bf16 v42, v106, v14, v42
  v_dot2_f32_bf16 v42, v107, v15, v42
  v_add_f32_dpp v40, v40, v40 row_ror:8 row_mask:0xf bank_mask:0x3
  v_add_f32_dpp v40, v41, v41 row_ror:8 row_mask:0xf bank_mask:0xc
  s_waitcnt vmcnt(6)
  s_cbranch_vccnz L_m_12
  s_waitcnt vmcnt(4)
L_m_12:
  buffer_load_dwordx4 v[72:75], v10, s[44:47], s8 offen nt
  s_add_u32 s8, s8, 4096
  v_dot2_f32_bf16 v43, v108, v12, 0
  v_dot2_f32_bf16 v43, v109, v13, v43
  v_dot2_f32_bf16 v43, v110, v14, v43
  v_dot2_f32_bf16 v43, v111, v15, v43
  v_cndmask_b32 v16, v36, v32, s[10:11]
  v_cndmask_b32 v17, v32, v36, s[10:11]
  s_nop 1
  v_add_f32_dpp v32, v16, v17 quad_perm:[1,0,3,2] row_mask:0xf bank_mask:0xf
  s_waitcnt vmcnt(6)
  s_cbranch_vccnz L_m_13
  s_waitcnt vmcnt(4)
L_m_13:
  buffer_load_dwordx4 v[76:79], v10, s[44:47], s8 offen nt
  s_add_u32 s8, s8, 4096
  v_dot2_f32_bf16 v44, v112, v12, 0
  v_dot2_f32_bf16 v44, v113, v13, v44
  v_dot2_f32_bf16 v44, v114, v14, v44
  v_dot2_f32_bf16 v44, v115, v15, v44
  v_add_f32_dpp v42, v42, v42 row_ror:8 row_mask:0xf bank_mask:0x3
  v_add_f32_dpp v42, v43, v43 row_ror:8 row_mask:0xf bank_mask:0xc
  s_waitcnt vmcnt(6)
  s_cbranch_vccnz L_m_14
  s_waitcnt vmcnt(4)
L_m_14:
  buffer_load_dwordx4 v[80:83], v10, s[44:47], s8 offen nt
  s_add_u32 s8, s8, 4096
  v_dot2_f32_bf16 v45, v116, v12, 0
  v_dot2_f32_bf16 v45, v117, v13, v45
  v_dot2_f32_bf16 v45, v118, v14, v45
  v_dot2_f32_bf16 v45, v119, v15, v45
  v_add_f32_dpp v40, v40, v40 row_half_mirror row_mask:0xf bank_mask:0x5
  v_add_f32_dpp v40, v42, v42 row_half_mirror row_mask:0xf bank_mask:0xa
  s_waitcnt vmcnt(6)
  s_cbranch_vccnz L_m_15
  s_waitcnt vmcnt(4)
L_m_15:
  buffer_load_dwordx4 v[84:87], v10, s[44:47], s8 offen nt
  s_add_u32 s8, s8, 4096
  v_dot2_f32_bf16 v46, v120, v12, 0
  v_dot2_f32_bf16 v46, v121, v13, v46
  v_dot2_f32_bf16 v46, v122, v14, v46
  v_dot2_f32_bf16 v46, v123, v15, v46
  v_add_f32_dpp v44, v44, v44 row_ror:8 row_mask:0xf bank_mask:0x3
  v_add_f32_dpp v44, v45, v45 row_ror:8 row_mask:0xf bank_mask:0xc
  s_waitcnt vmcnt(6)
  s_cbranch_vccnz L_m_16
  s_waitcnt vmcnt(4)
L_m_16:
  buffer_load_dwordx4 v[88:91], v10, s[44:47], s8 offen nt
  s_add_u32 s8, s8, 4096
  v_dot2_f32_bf16 v47, v124, v12, 0
  v_dot2_f32_bf16 v47, v125, v13, v47
  v_dot2_f32_bf16 v47, v126, v14, v47
  v_dot2_f32_bf16 v47, v127, v15, v47
  s_nop 2
  v_add_f32_dpp v46, v46, v46 row_ror:8 row_mask:0xf bank_mask:0x3
  v_add_f32_dpp v46, v47, v47 row_ror:8 row_mask:0xf bank_mask:0xc
  s_nop 1
  v_add_f32_dpp v44, v44, v44 row_half_mirror row_mask:0xf bank_mask:0x5
  v_add_f32_dpp v44, v46, v46 row_half_mirror row_mask:0xf bank_mask:0xa
  s_nop 0
  v_cndmask_b32 v16, v44, v40, s[10:11]
  v_cndmask_b32 v17, v40, v44, s[10:11]
  s_nop 1
  v_add_f32_dpp v40, v16, v17 quad_perm:[1,0,3,2] row_mask:0xf bank_mask:0xf
  s_nop 0
  v_cndmask_b32 v16, v40, v32, s[12:13]
  v_cndmask_b32 v17, v32, v40, s[12:13]
  s_nop 1
  v_add_f32_dpp v32, v16, v17 quad_perm:[2,3,0,1] row_mask:0xf bank_mask:0xf
  v_cvt_pk_bf16_f32 v32, v32, v32
  v_and_b32 v32, 0xffff0000, v32
  v_mul_f32 v32, s14, v32
  v_cvt_pk_bf16_f32 v32, v32, v32
  v_and_b32 v32, 0xffff0000, v32
  ds_write_b32 v20, v32
  v_add_u32 v20, 256, v20
  v_max_f32 v16, v18, v32
  v_sub_f32 v17, v18, v16
  v_sub_f32 v32, v32, v16
  v_mul_f32 v17, s15, v17
  v_mul_f32 v32, s15, v32
  v_exp_f32 v17, v17
  v_exp_f32 v32, v32
  v_mov_b32 v18, v16
  v_fma_f32 v19, v19, v17, v32
  s_sub_u32 s9, s9, 1
  s_cmp_lg_u32 s9, 0
  s_cbranch_scc1 L_kloop
  s_waitcnt lgkmcnt(0)
  v_readfirstlane_b32 s43, v11
  v_mov_b32 v16, s42
  ds_write_b32 v23, v16
  ds_read_b32 v11, v9 offset:4184
  s_cmp_lt_u32 s42, s43
  s_cselect_b64 vcc, -1, 0
  s_add_u32 s42, s42, 1
  s_waitcnt vmcnt(6)
  s_cbranch_vccnz L_m_17
  s_waitcnt vmcnt(4)
L_m_17:
  buffer_load_dwordx4 v[92:95], v10, s[44:47], s8 offen nt
  s_add_u32 s8, s8, 4096
  v_dot2_f32_bf16 v32, v64, v12, 0
  v_dot2_f32_bf16 v32, v65, v13, v32
  v_dot2_f32_bf16 v32, v66, v14, v32
  v_dot2_f32_bf16 v32, v67, v15, v32
  s_waitcnt vmcnt(6)
  s_cbranch_vccnz L_m_18
  s_waitcnt vmcnt(4)
L_m_18:
  buffer_load_dwordx4 v[96:99], v10, s[44:47], s8 offen nt
  s_add_u32 s8, s8, 4096
  v_dot2_f32_bf16 v33, v68, v12, 0
  v_dot2_f32_bf16 v33, v69, v13, v33
  v_dot2_f32_bf16 v33, v70, v14, v33
  v_dot2_f32_bf16 v33, v71, v15, v33
  s_waitcnt vmcnt(6)
  s_cbranch_vccnz L_m_19
  s_waitcnt vmcnt(4)
L_m_19:
  buffer_load_dwordx4 v[100:103], v10, s[44:47], s8 offen nt
  s_add_u32 s8, s8, 4096
  v_dot2_f32_bf16 v34, v72, v12, 0
  v_dot2_f32_bf16 v34, v73, v13, v34
  v_dot2_f32_bf16 v34, v74, v14, v34
  v_dot2_f32_bf16 v34, v75, v15, v34
  v_add_f32_dpp v32, v32, v32 row_ror:8 row_mask:0xf bank_mask:0x3
  v_add_f32_dpp v32, v33, v33 row_ror:8 row_mask:0xf bank_mask:0xc
  s_waitcnt vmcnt(6)
  s_cbranch_vccnz L_m_20
  s_waitcnt vmcnt(4)
L_m_20:
  buffer_load_dwordx4 v[104:107], v10, s[44:47], s8 offen nt
  s_add_u32 s8, s8, 4096
  v_dot2_f32_bf16 v35, v76, v12, 0
  v_dot2_f32_bf16 v35, v77, v13, v35
  v_dot2_f32_bf16 v35, v78, v14, v35
  v_dot2_f32_bf16 v35, v79, v15, v35
  s_waitcnt vmcnt(6)
  s_cbranch_vccnz L_m_21
  s_waitcnt vmcnt(4)
L_m_21:
  buffer_load_dwordx4 v[108:111], v10, s[44:47], s8 offen nt
  s_add_u32 s8, s8, 4096
  v_dot2_f32_bf16 v36, v80, v12, 0
  v_dot2_f32_bf16 v36, v81, v13, v36
  v_dot2_f32_bf16 v36, v82, v14, v36
  v_dot2_f32_bf16 v36, v83, v15, v36
  v_add_f32_dpp v34, v34, v34 row_ror:8 row_mask:0xf bank_mask:0x3
  v_add_f32_dpp v34, v35, v35 row_ror:8 row_mask:0xf bank_mask:0xc
  s_waitcnt vmcnt(6)
  s_cbranch_vccnz L_m_22
  s_waitcnt vmcnt(4)
L_m_22:
  buffer_load_dwordx4 v[112:115], v10, s[44:47], s8 offen nt
  s_add_u32 s8, s8, 4096
  v_dot2_f32_bf16 v37, v84, v12, 0
  v_dot2_f32_bf16 v37, v85, v13, v37
  v_dot2_f32_bf16 v37, v86, v14, v37
  v_dot2_f32_bf16 v37, v87, v15, v37
  v_add_f32_dpp v32, v32, v32 row_half_mirror row_mask:0xf bank_mask:0x5
  v_add_f32_dpp v32, v34, v34 row_half_mirror row_mask:0xf bank_mask:0xa
  s_waitcnt vmcnt(6)
  s_cbranch_vccnz L_m_23
  s_waitcnt vmcnt(4)
L_m_23:
  buffer_load_dwordx4 v[116:119], v10, s[44:47], s8 offen nt
  s_add_u32 s8, s8, 4096
  v_dot2_f32_bf16 v38, v88, v12, 0
  v_dot2_f32_bf16 v38, v89, v13, v38
  v_dot2_f32_bf16 v38, v90, v14, v38
  v_dot2_f32_bf16 v38, v91, v15, v38
  v_add_f32_dpp v36, v36, v36 row_ror:8 row_mask:0xf bank_mask:0x3
  v_add_f32_dpp v36, v37, v37 row_ror:8 row_mask:0xf bank_mask:0xc
  s_waitcnt vmcnt(6)
  s_cbranch_vccnz L_m_24
  s_waitcnt vmcnt(4)
L_m_24:
  buffer_load_dwordx4 v[120:123], v10, s[44:47], s8 offen nt
  s_add_u32 s8, s8, 4096
  v_dot2_f32_bf16 v39, v92, v12, 0
  v_dot2_f32_bf16 v39, v93, v13, v39
  v_dot2_f32_bf16 v39, v94, v14, v39
  v_dot2_f32_bf16 v39, v95, v15, v39
  s_waitcnt vmcnt(6)
  s_cbranch_vccnz L_m_25
  s_waitcnt vmcnt(4)
L_m_25:
  buffer_load_dwordx4 v[124:127], v10, s[44:47], s8 offen nt
  s_add_u32 s8, s8, 4096
  v_dot2_f32_bf16 v40, v96, v12, 0
  v_dot2_f32_bf16 v40, v97, v13, v40
  v_dot2_f32_bf16 v40, v98, v14, v40
  v_dot2_f32_bf16 v40, v99, v15, v40
  v_add_f32_dpp v38, v38, v38 row_ror:8 row_mask:0xf bank_mask:0x3
  v_add_f32_dpp v38, v39, v39 row_ror:8 row_mask:0xf bank_mask:0xc
  s_waitcnt vmcnt(6)
  s_cbranch_vccnz L_m_26
  s_waitcnt vmcnt(4)
L_m_26:
  s_mov_b32 s8, 0
  buffer_load_dwordx4 v[64:67], v10, s[48:51], s8 offen nt
  s_add_u32 s8, s8, 4096
  v_dot2_f32_bf16 v41, v100, v12, 0
  v_dot2_f32_bf16 v41, v101, v13, v41
  v_dot2_f32_bf16 v41, v102, v14, v41
  v_dot2_f32_bf16 v41, v103, v15, v41
  v_add_f32_dpp v36, v36, v36 row_half_mirror row_mask:0xf bank_mask:0x5
  v_add_f32_dpp v36, v38, v38 row_half_mirror row_mask:0xf bank_mask:0xa
  s_waitcnt vmcnt(6)
  s_cbranch_vccnz L_m_27
  s_waitcnt vmcnt(4)
L_m_27:
  buffer_load_dwordx4 v[68:71], v10, s[48:51], s8 offen nt
  s_add_u32 s8, s8, 4096
  v_dot2_f32_bf16 v42, v104, v12, 0
  v_dot2_f32_bf16 v42, v105, v13, v42
  v_dot2_f32_bf16 v42, v106, v14, v42
  v_dot2_f32_bf16 v42, v107, v15, v42
  v_add_f32_dpp v40, v40, v40 row_ror:8 row_mask:0xf bank_mask:0x3
  v_add_f32_dpp v40, v41, v41 row_ror:8 row_mask:0xf bank_mask:0xc
  s_waitcnt vmcnt(6)
  s_cbranch_vccnz L_m_28
  s_waitcnt vmcnt(4)
L_m_28:
  buffer_load_dwordx4 v[72:75], v10, s[48:51], s8 offen nt
  s_add_u32 s8, s8, 4096
  v_dot2_f32_bf16 v43, v108, v12, 0
  v_dot2_f32_bf16 v43, v109, v13, v43
  v_dot2_f32_bf16 v43, v110, v14, v43
  v_dot2_f32_bf16 v43, v111, v15, v43
  v_cndmask_b32 v16, v36, v32, s[10:11]
  v_cndmask_b32 v17, v32, v36, s[10:11]
  s_nop 1
  v_add_f32_dpp v32, v16, v17 quad_perm:[1,0,3,2] row_mask:0xf bank_mask:0xf
  s_waitcnt vmcnt(6)
  s_cbranch_vccnz L_m_29
  s_waitcnt vmcnt(4)
L_m_29:
  buffer_load_dwordx4 v[76:79], v10, s[48:51], s8 offen nt
  s_add_u32 s8, s8, 4096
  v_dot2_f32_bf16 v44, v112, v12, 0
  v_dot2_f32_bf16 v44, v113, v13, v44
  v_dot2_f32_bf16 v44, v114, v14, v44
  v_dot2_f32_bf16 v44, v115, v15, v44
  v_add_f32_dpp v42, v42, v42 row_ror:8 row_mask:0xf bank_mask:0x3
  v_add_f32_dpp v42, v43, v43 row_ror:8 row_mask:0xf bank_mask:0xc
  s_waitcnt vmcnt(6)
  s_cbranch_vccnz L_m_30
  s_waitcnt vmcnt(4)
L_m_30:
  buffer_load_dwordx4 v[80:83], v10, s[48:51], s8 offen nt
  s_add_u32 s8, s8, 4096
  v_dot2_f32_bf16 v45, v116, v12, 0
  v_dot2_f32_bf16 v45, v117, v13, v45
  v_dot2_f32_bf16 v45, v118, v14, v45
  v_dot2_f32_bf16 v45, v119, v15, v45
  v_add_f32_dpp v40, v40, v40 row_half_mirror row_mask:0xf bank_mask:0x5
  v_add_f32_dpp v40, v42, v42 row_half_mirror row_mask:0xf bank_mask:0xa
  s_waitcnt vmcnt(6)
  s_cbranch_vccnz L_m_31
  s_waitcnt vmcnt(4)
L_m_31:
  buffer_load_dwordx4 v[84:87], v10, s[48:51], s8 offen nt
  s_add_u32 s8, s8, 4096
  v_dot2_f32_bf16 v46, v120, v12, 0
  v_dot2_f32_bf16 v46, v121, v13, v46
  v_dot2_f32_bf16 v46, v122, v14, v46
  v_dot2_f32_bf16 v46, v123, v15, v46
  v_add_f32_dpp v44, v44, v44 row_ror:8 row_mask:0xf bank_mask:0x3
  v_add_f32_dpp v44, v45, v45 row_ror:8 row_mask:0xf bank_mask:0xc
  s_waitcnt vmcnt(6)
  s_cbranch_vccnz L_m_32
  s_waitcnt vmcnt(4)
L_m_32:
  buffer_load_dwordx4 v[88:91], v10, s[48:51], s8 offen nt
  s_add_u32 s8, s8, 4096
  v_dot2_f32_bf16 v47, v124, v12, 0
  v_dot2_f32_bf16 v47, v125, v13, v47
  v_dot2_f32_bf16 v47, v126, v14, v47
  v_dot2_f32_bf16 v47, v127, v15, v47
  s_nop 2
  v_add_f32_dpp v46, v46, v46 row_ror:8 row_mask:0xf bank_mask:0x3
  v_add_f32_dpp v46, v47, v47 row_ror:8 row_mask:0xf bank_mask:0xc
  s_nop 1
  v_add_f32_dpp v44, v44, v44 row_half_mirror row_mask:0xf bank_mask:0x5
  v_add_f32_dpp v44, v46, v46 row_half_mirror row_mask:0xf bank_mask:0xa
  s_nop 0
  v_cndmask_b32 v16, v44, v40, s[10:11]
  v_cndmask_b32 v17, v40, v44, s[10:11]
  s_nop 1
  v_add_f32_dpp v40, v16, v17 quad_perm:[1,0,3,2] row_mask:0xf bank_mask:0xf
  s_nop 0
  v_cndmask_b32 v16, v40, v32, s[12:13]
  v_cndmask_b32 v17, v32, v40, s[12:13]
  s_nop 1
  v_add_f32_dpp v32, v16, v17 quad_perm:[2,3,0,1] row_mask:0xf bank_mask:0xf
  v_cvt_pk_bf16_f32 v32, v32, v32
  v_and_b32 v32, 0xffff0000, v32
  v_mul_f32 v32, s14, v32
  v_cvt_pk_bf16_f32 v32, v32, v32
  v_and_b32 v32, 0xffff0000, v32
  ds_write_b32 v20, v32
  v_add_u32 v20, 256, v20
  v_max_f32 v16, v18, v32
  v_sub_f32 v17, v18, v16
  v_sub_f32 v32, v32, v16
  v_mul_f32 v17, s15, v17
  v_mul_f32 v32, s15, v32
  v_exp_f32 v17, v17
  v_exp_f32 v32, v32
  v_mov_b32 v18, v16
  v_fma_f32 v19, v19, v17, v32
  v_subrev_u32 v20, 8192, v20
  ds_read_b32 v22, v20
  v_mov_b32 v32, v18
  s_nop 1
  v_max_f32_dpp v32, v32, v32 quad_perm:[1,0,3,2] row_mask:0xf bank_mask:0xf
  s_nop 1
  v_max_f32_dpp v32, v32, v32 quad_perm:[2,3,0,1] row_mask:0xf bank_mask:0xf
  s_nop 1
  v_max_f32_dpp v32, v32, v32 row_half_mirror row_mask:0xf bank_mask:0xf
  s_nop 1
  v_max_f32_dpp v32, v32, v32 row_mirror row_mask:0xf bank_mask:0xf
  v_mov_b32 v16, v32
  s_nop 1
  v_permlane16_swap_b32 v32, v16
  s_nop 0
  v_max_f32 v32, v32, v16
  v_mov_b32 v16, v32
  s_nop 1
  v_permlane32_swap_b32 v32, v16
  s_nop 0
  v_max_f32 v32, v32, v16
  v_sub_f32 v17, v18, v32
  v_mul_f32 v17, s15, v17
  v_exp_f32 v17, v17
  v_mov_b32 v18, v32
  v_mul_f32 v33, v19, v17
  s_nop 1
  v_add_f32_dpp v33, v33, v33 quad_perm:[1,0,3,2] row_mask:0xf bank_mask:0xf
  s_nop 1
  v_add_f32_dpp v33, v33, v33 quad_perm:[2,3,0,1] row_mask:0xf bank_mask:0xf
  s_nop 1
  v_add_f32_dpp v33, v33, v33 row_half_mirror row_mask:0xf bank_mask:0xf
  s_nop 1
  v_add_f32_dpp v33, v33, v33 row_mirror row_mask:0xf bank_mask:0xf
  v_mov_b32 v16, v33
  s_nop 1
  v_permlane16_swap_b32 v33, v16
  s_nop 0
  v_add_f32 v33, v33, v16
  v_mov_b32 v16, v33
  s_nop 1
  v_permlane32_swap_b32 v33, v16
  s_nop 0
  v_add_f32 v33, v33, v16
  v_mov_b32 v34, 1
  v_mov_b32 v35, 0
  s_lshl_b32 s7, s3, 4
  s_add_u32 s7, s7, 4096
  v_mov_b32 v16, s7
  s_mov_b64 exec, 1
  ds_write_b128 v16, v[32:35]
  s_mov_b64 exec, -1
  s_mov_b32 s9, 31
L_vloop:
  s_waitcnt lgkmcnt(0)
  v_readfirstlane_b32 s43, v11
  v_mov_b32 v16, s42
  ds_write_b32 v23, v16
  ds_read_b32 v11, v9 offset:4184
  s_cmp_lt_u32 s42, s43
  s_cselect_b64 vcc, -1, 0
  s_add_u32 s42, s42, 1
  v_sub_f32 v21, v22, v18
  v_mul_f32 v21, s15, v21
  v_exp_f32 v21, v21
  v_add_u32 v20, 256, v20
  ds_read_b32 v22, v20
  v_cvt_pk_bf16_f32 v21, v21, v21
  s_nop 1
  v_and_b32_dpp v24, v21, v4 row_newbcast:0 row_mask:0xf bank_mask:0xf
  v_and_b32_dpp v25, v21, v5 row_newbcast:0 row_mask:0xf bank_mask:0xf
  v_and_b32_dpp v26, v21, v6 row_newbcast:0 row_mask:0xf bank_mask:0xf
  v_and_b32_dpp v27, v21, v7 row_newbcast:0 row_mask:0xf bank_mask:0xf
  s_waitcnt vmcnt(6)
  s_cbranch_vccnz L_m_33
  s_waitcnt vmcnt(4)
L_m_33:
  buffer_load_dwordx4 v[92:95], v10, s[48:51], s8 offen nt
  s_add_u32 s8, s8, 4096
  v_mfma_f32_16x16x32_bf16 v[48:51], v[24:27], v[64:67], v[48:51]
  v_and_b32_dpp v28, v21, v4 row_newbcast:8 row_mask:0xf bank_mask:0xf
  v_and_b32_dpp v29, v21, v5 row_newbcast:8 row_mask:0xf bank_mask:0xf
  v_and_b32_dpp v30, v21, v6 row_newbcast:8 row_mask:0xf bank_mask:0xf
  v_and_b32_dpp v31, v21, v7 row_newbcast:8 row_mask:0xf bank_mask:0xf
  s_waitcnt vmcnt(6)
  s_cbranch_vccnz L_m_34
  s_waitcnt vmcnt(4)
L_m_34:
  buffer_load_dwordx4 v[96:99], v10, s[48:51], s8 offen nt
  s_add_u32 s8, s8, 4096
  v_mfma_f32_16x16x32_bf16 v[48:51], v[28:31], v[68:71], v[48:51]
  v_and_b32_dpp v24, v21, v4 row_newbcast:4 row_mask:0xf bank_mask:0xf
  v_and_b32_dpp v25, v21, v5 row_newbcast:4 row_mask:0xf bank_mask:0xf
  v_and_b32_dpp v26, v21, v6 row_newbcast:4 row_mask:0xf bank_mask:0xf
  v_and_b32_dpp v27, v21, v7 row_newbcast:4 row_mask:0xf bank_mask:0xf
  s_waitcnt vmcnt(6)
  s_cbranch_vccnz L_m_35
  s_waitcnt vmcnt(4)
L_m_35:
  buffer_load_dwordx4 v[100:103], v10, s[48:51], s8 offen nt
  s_add_u32 s8, s8, 4096
  v_mfma_f32_16x16x32_bf16 v[48:51], v[24:27], v[72:75], v[48:51]
  v_and_b32_dpp v28, v21, v4 row_newbcast:12 row_mask:0xf bank_mask:0xf
  v_and_b32_dpp v29, v21, v5 row_newbcast:12 row_mask:0xf bank_mask:0xf
  v_and_b32_dpp v30, v21, v6 row_newbcast:12 row_mask:0xf bank_mask:0xf
  v_and_b32_dpp v31, v21, v7 row_newbcast:12 row_mask:0xf bank_mask:0xf
  s_waitcnt vmcnt(6)
  s_cbranch_vccnz L_m_36
  s_waitcnt vmcnt(4)
L_m_36:
  buffer_load_dwordx4 v[104:107], v10, s[48:51], s8 offen nt
  s_add_u32 s8, s8, 4096
  v_mfma_f32_16x16x32_bf16 v[48:51], v[28:31], v[76:79], v[48:51]
  v_and_b32_dpp v24, v21, v4 row_newbcast:1 row_mask:0xf bank_mask:0xf
  v_and_b32_dpp v25, v21, v5 row_newbcast:1 row_mask:0xf bank_mask:0xf
  v_and_b32_dpp v26, v21, v6 row_newbcast:1 row_mask:0xf bank_mask:0xf
  v_and_b32_dpp v27, v21, v7 row_newbcast:1 row_mask:0xf bank_mask:0xf
  s_waitcnt vmcnt(6)
  s_cbranch_vccnz L_m_37
  s_waitcnt vmcnt(4)
L_m_37:
  buffer_load_dwordx4 v[108:111], v10, s[48:51], s8 offen nt
  s_add_u32 s8, s8, 4096
  v_mfma_f32_16x16x32_bf16 v[48:51], v[24:27], v[80:83], v[48:51]
  v_and_b32_dpp v28, v21, v4 row_newbcast:9 row_mask:0xf bank_mask:0xf
  v_and_b32_dpp v29, v21, v5 row_newbcast:9 row_mask:0xf bank_mask:0xf
  v_and_b32_dpp v30, v21, v6 row_newbcast:9 row_mask:0xf bank_mask:0xf
  v_and_b32_dpp v31, v21, v7 row_newbcast:9 row_mask:0xf bank_mask:0xf
  s_waitcnt vmcnt(6)
  s_cbranch_vccnz L_m_38
  s_waitcnt vmcnt(4)
L_m_38:
  buffer_load_dwordx4 v[112:115], v10, s[48:51], s8 offen nt
  s_add_u32 s8, s8, 4096
  v_mfma_f32_16x16x32_bf16 v[48:51], v[28:31], v[84:87], v[48:51]
  v_and_b32_dpp v24, v21, v4 row_newbcast:5 row_mask:0xf bank_mask:0xf
  v_and_b32_dpp v25, v21, v5 row_newbcast:5 row_mask:0xf bank_mask:0xf
  v_and_b32_dpp v26, v21, v6 row_newbcast:5 row_mask:0xf bank_mask:0xf
  v_and_b32_dpp v27, v21, v7 row_newbcast:5 row_mask:0xf bank_mask:0xf
  s_waitcnt vmcnt(6)
  s_cbranch_vccnz L_m_39
  s_waitcnt vmcnt(4)
L_m_39:
  buffer_load_dwordx4 v[116:119], v10, s[48:51], s8 offen nt
  s_add_u32 s8, s8, 4096
  v_mfma_f32_16x16x32_bf16 v[48:51], v[24:27], v[88:91], v[48:51]
  v_and_b32_dpp v28, v21, v4 row_newbcast:13 row_mask:0xf bank_mask:0xf
  v_and_b32_dpp v29, v21, v5 row_newbcast:13 row_mask:0xf bank_mask:0xf
  v_and_b32_dpp v30, v21, v6 row_newbcast:13 row_mask:0xf bank_mask:0xf
  v_and_b32_dpp v31, v21, v7 row_newbcast:13 row_mask:0xf bank_mask:0xf
  s_waitcnt vmcnt(6)
  s_cbranch_vccnz L_m_40
  s_waitcnt vmcnt(4)
L_m_40:
  buffer_load_dwordx4 v[120:123], v10, s[48:51], s8 offen nt
  s_add_u32 s8, s8, 4096
  v_mfma_f32_16x16x32_bf16 v[48:51], v[28:31], v[92:95], v[48:51]
  v_and_b32_dpp v24, v21, v4 row_newbcast:2 row_mask:0xf bank_mask:0xf
  v_and_b32_dpp v25, v21, v5 row_newbcast:2 row_mask:0xf bank_mask:0xf
  v_and_b32_dpp v26, v21, v6 row_newbcast:2 row_mask:0xf bank_mask:0xf
  v_and_b32_dpp v27, v21, v7 row_newbcast:2 row_mask:0xf bank_mask:0xf
  s_waitcnt vmcnt(6)
  s_cbranch_vccnz L_m_41
  s_waitcnt vmcnt(4)
L_m_41:
  buffer_load_dwordx4 v[124:127], v10, s[48:51], s8 offen nt
  s_add_u32 s8, s8, 4096
  v_mfma_f32_16x16x32_bf16 v[48:51], v[24:27], v[96:99], v[48:51]
  v_and_b32_dpp v28, v21, v4 row_newbcast:10 row_mask:0xf bank_mask:0xf
  v_and_b32_dpp v29, v21, v5 row_newbcast:10 row_mask:0xf bank_mask:0xf
  v_and_b32_dpp v30, v21, v6 row_newbcast:10 row_mask:0xf bank_mask:0xf
  v_and_b32_dpp v31, v21, v7 row_newbcast:10 row_mask:0xf bank_mask:0xf
  s_waitcnt vmcnt(6)
  s_cbranch_vccnz L_m_42
  s_waitcnt vmcnt(4)
L_m_42:
  buffer_load_dwordx4 v[64:67], v10, s[48:51], s8 offen nt
  s_add_u32 s8, s8, 4096
  v_mfma_f32_16x16x32_bf16 v[48:51], v[28:31], v[100:103], v[48:51]
  v_and_b32_dpp v24, v21, v4 row_newbcast:6 row_mask:0xf bank_mask:0xf
  v_and_b32_dpp v25, v21, v5 row_newbcast:6 row_mask:0xf bank_mask:0xf
  v_and_b32_dpp v26, v21, v6 row_newbcast:6 row_mask:0xf bank_mask:0xf
  v_and_b32_dpp v27, v21, v7 row_newbcast:6 row_mask:0xf bank_mask:0xf
  s_waitcnt vmcnt(6)
  s_cbranch_vccnz L_m_43
  s_waitcnt vmcnt(4)
L_m_43:
  buffer_load_dwordx4 v[68:71], v10, s[48:51], s8 offen nt
  s_add_u32 s8, s8, 4096
  v_mfma_f32_16x16x32_bf16 v[48:51], v[24:27], v[104:107], v[48:51]
  v_and_b32_dpp v28, v21, v4 row_newbcast:14 row_mask:0xf bank_mask:0xf
  v_and_b32_dpp v29, v21, v5 row_newbcast:14 row_mask:0xf bank_mask:0xf
  v_and_b32_dpp v30, v21, v6 row_newbcast:14 row_mask:0xf bank_mask:0xf
  v_and_b32_dpp v31, v21, v7 row_newbcast:14 row_mask:0xf bank_mask:0xf
  s_waitcnt vmcnt(6)
  s_cbranch_vccnz L_m_44
  s_waitcnt vmcnt(4)
L_m_44:
  buffer_load_dwordx4 v[72:75], v10, s[48:51], s8 offen nt
  s_add_u32 s8, s8, 4096
  v_mfma_f32_16x16x32_bf16 v[48:51], v[28:31], v[108:111], v[48:51]
  v_and_b32_dpp v24, v21, v4 row_newbcast:3 row_mask:0xf bank_mask:0xf
  v_and_b32_dpp v25, v21, v5 row_newbcast:3 row_mask:0xf bank_mask:0xf
  v_and_b32_dpp v26, v21, v6 row_newbcast:3 row_mask:0xf bank_mask:0xf
  v_and_b32_dpp v27, v21, v7 row_newbcast:3 row_mask:0xf bank_mask:0xf
  s_waitcnt vmcnt(6)
  s_cbranch_vccnz L_m_45
  s_waitcnt vmcnt(4)
L_m_45:
  buffer_load_dwordx4 v[76:79], v10, s[48:51], s8 offen nt
  s_add_u32 s8, s8, 4096
  v_mfma_f32_16x16x32_bf16 v[48:51], v[24:27], v[112:115], v[48:51]
  v_and_b32_dpp v28, v21, v4 row_newbcast:11 row_mask:0xf bank_mask:0xf
  v_and_b32_dpp v29, v21, v5 row_newbcast:11 row_mask:0xf bank_mask:0xf
  v_and_b32_dpp v30, v21, v6 row_newbcast:11 row_mask:0xf bank_mask:0xf
  v_and_b32_dpp v31, v21, v7 row_newbcast:11 row_mask:0xf bank_mask:0xf
  s_waitcnt vmcnt(6)
  s_cbranch_vccnz L_m_46
  s_waitcnt vmcnt(4)
L_m_46:
  buffer_load_dwordx4 v[80:83], v10, s[48:51], s8 offen nt
  s_add_u32 s8, s8, 4096
  v_mfma_f32_16x16x32_bf16 v[48:51], v[28:31], v[116:119], v[48:51]
  v_and_b32_dpp v24, v21, v4 row_newbcast:7 row_mask:0xf bank_mask:0xf
  v_and_b32_dpp v25, v21, v5 row_newbcast:7 row_mask:0xf bank_mask:0xf
  v_and_b32_dpp v26, v21, v6 row_newbcast:7 row_mask:0xf bank_mask:0xf
  v_and_b32_dpp v27, v21, v7 row_newbcast:7 row_mask:0xf bank_mask:0xf
  s_waitcnt vmcnt(6)
  s_cbranch_vccnz L_m_47
  s_waitcnt vmcnt(4)
L_m_47:
  buffer_load_dwordx4 v[84:87], v10, s[48:51], s8 offen nt
  s_add_u32 s8, s8, 4096
  v_mfma_f32_16x16x32_bf16 v[48:51], v[24:27], v[120:123], v[48:51]
  v_and_b32_dpp v28, v21, v4 row_newbcast:15 row_mask:0xf bank_mask:0xf
  v_and_b32_dpp v29, v21, v5 row_newbcast:15 row_mask:0xf bank_mask:0xf
  v_and_b32_dpp v30, v21, v6 row_newbcast:15 row_mask:0xf bank_mask:0xf
  v_and_b32_dpp v31, v21, v7 row_newbcast:15 row_mask:0xf bank_mask:0xf
  s_waitcnt vmcnt(6)
  s_cbranch_vccnz L_m_48
  s_waitcnt vmcnt(4)
L_m_48:
  buffer_load_dwordx4 v[88:91], v10, s[48:51], s8 offen nt
  s_add_u32 s8, s8, 4096
  v_mfma_f32_16x16x32_bf16 v[48:51], v[28:31], v[124:127], v[48:51]
  s_cmp_lg_u32 s9, 8
  s_cbranch_scc1 L_notrig
  v_mov_b32 v16, 4176
  v_mov_b32 v17, 1
  ds_write_b32 v16, v17
L_notrig:
  s_sub_u32 s9, s9, 1
  s_cmp_lg_u32 s9, 0
  s_cbranch_scc1 L_vloop
  s_lshl_b32 s7, s3, 9
  s_add_u32 s7, s7, 2048
  v_lshlrev_b32 v16, 5, v1
  v_lshlrev_b32 v17, 4, v2
  v_add3_u32 v16, v16, v17, s7
  s_waitcnt lgkmcnt(0)
  v_sub_f32 v21, v22, v18
  v_mul_f32 v21, s15, v21
  v_exp_f32 v21, v21
  s_nop 0
  v_cvt_pk_bf16_f32 v21, v21, v21
  s_nop 1
  v_and_b32_dpp v24, v21, v4 row_newbcast:0 row_mask:0xf bank_mask:0xf
  v_and_b32_dpp v25, v21, v5 row_newbcast:0 row_mask:0xf bank_mask:0xf
  v_and_b32_dpp v26, v21, v6 row_newbcast:0 row_mask:0xf bank_mask:0xf
  v_and_b32_dpp v27, v21, v7 row_newbcast:0 row_mask:0xf bank_mask:0xf
  s_waitcnt vmcnt(6)
  s_cbranch_vccnz L_m_49
  s_waitcnt vmcnt(4)
L_m_49:
  buffer_load_dwordx4 v[92:95], v10, s[48:51], s8 offen nt
  s_add_u32 s8, s8, 4096
  v_mfma_f32_16x16x32_bf16 v[48:51], v[24:27], v[64:67], v[48:51]
  v_and_b32_dpp v28, v21, v4 row_newbcast:8 row_mask:0xf bank_mask:0xf
  v_and_b32_dpp v29, v21, v5 row_newbcast:8 row_mask:0xf bank_mask:0xf
  v_and_b32_dpp v30, v21, v6 row_newbcast:8 row_mask:0xf bank_mask:0xf
  v_and_b32_dpp v31, v21, v7 row_newbcast:8 row_mask:0xf bank_mask:0xf
  s_waitcnt vmcnt(6)
  s_cbranch_vccnz L_m_50
  s_waitcnt vmcnt(4)
L_m_50:
  buffer_load_dwordx4 v[96:99], v10, s[48:51], s8 offen nt
  s_add_u32 s8, s8, 4096
  v_mfma_f32_16x16x32_bf16 v[48:51], v[28:31], v[68:71], v[48:51]
  v_and_b32_dpp v24, v21, v4 row_newbcast:4 row_mask:0xf bank_mask:0xf
  v_and_b32_dpp v25, v21, v5 row_newbcast:4 row_mask:0xf bank_mask:0xf
  v_and_b32_dpp v26, v21, v6 row_newbcast:4 row_mask:0xf bank_mask:0xf
  v_and_b32_dpp v27, v21, v7 row_newbcast:4 row_mask:0xf bank_mask:0xf
  s_waitcnt vmcnt(6)
  s_cbranch_vccnz L_m_51
  s_waitcnt vmcnt(4)
L_m_51:
  buffer_load_dwordx4 v[100:103], v10, s[48:51], s8 offen nt
  s_add_u32 s8, s8, 4096
  v_mfma_f32_16x16x32_bf16 v[48:51], v[24:27], v[72:75], v[48:51]
  v_and_b32_dpp v28, v21, v4 row_newbcast:12 row_mask:0xf bank_mask:0xf
  v_and_b32_dpp v29, v21, v5 row_newbcast:12 row_mask:0xf bank_mask:0xf
  v_and_b32_dpp v30, v21, v6 row_newbcast:12 row_mask:0xf bank_mask:0xf
  v_and_b32_dpp v31, v21, v7 row_newbcast:12 row_mask:0xf bank_mask:0xf
  s_waitcnt vmcnt(6)
  s_cbranch_vccnz L_m_52
  s_waitcnt vmcnt(4)
L_m_52:
  buffer_load_dwordx4 v[104:107], v10, s[48:51], s8 offen nt
  s_add_u32 s8, s8, 4096
  v_mfma_f32_16x16x32_bf16 v[48:51], v[28:31], v[76:79], v[48:51]
  v_and_b32_dpp v24, v21, v4 row_newbcast:1 row_mask:0xf bank_mask:0xf
  v_and_b32_dpp v25, v21, v5 row_newbcast:1 row_mask:0xf bank_mask:0xf
  v_and_b32_dpp v26, v21, v6 row_newbcast:1 row_mask:0xf bank_mask:0xf
  v_and_b32_dpp v27, v21, v7 row_newbcast:1 row_mask:0xf bank_mask:0xf
  s_waitcnt vmcnt(6)
  s_cbranch_vccnz L_m_53
  s_waitcnt vmcnt(4)
L_m_53:
  buffer_load_dwordx4 v[108:111], v10, s[48:51], s8 offen nt
  s_add_u32 s8, s8, 4096
  v_mfma_f32_16x16x32_bf16 v[48:51], v[24:27], v[80:83], v[48:51]
  v_and_b32_dpp v28, v21, v4 row_newbcast:9 row_mask:0xf bank_mask:0xf
  v_and_b32_dpp v29, v21, v5 row_newbcast:9 row_mask:0xf bank_mask:0xf
  v_and_b32_dpp v30, v21, v6 row_newbcast:9 row_mask:0xf bank_mask:0xf
  v_and_b32_dpp v31, v21, v7 row_newbcast:9 row_mask:0xf bank_mask:0xf
  s_waitcnt vmcnt(6)
  s_cbranch_vccnz L_m_54
  s_waitcnt vmcnt(4)
L_m_54:
  buffer_load_dwordx4 v[112:115], v10, s[48:51], s8 offen nt
  s_add_u32 s8, s8, 4096
  v_mfma_f32_16x16x32_bf16 v[48:51], v[28:31], v[84:87], v[48:51]
  v_and_b32_dpp v24, v21, v4 row_newbcast:5 row_mask:0xf bank_mask:0xf
  v_and_b32_dpp v25, v21, v5 row_newbcast:5 row_mask:0xf bank_mask:0xf
  v_and_b32_dpp v26, v21, v6 row_newbcast:5 row_mask:0xf bank_mask:0xf
  v_and_b32_dpp v27, v21, v7 row_newbcast:5 row_mask:0xf bank_mask:0xf
  s_waitcnt vmcnt(6)
  s_cbranch_vccnz L_m_55
  s_waitcnt vmcnt(4)
L_m_55:
  buffer_load_dwordx4 v[116:119], v10, s[48:51], s8 offen nt
  s_add_u32 s8, s8, 4096
  v_mfma_f32_16x16x32_bf16 v[48:51], v[24:27], v[88:91], v[48:51]
  v_and_b32_dpp v28, v21, v4 row_newbcast:13 row_mask:0xf bank_mask:0xf
  v_and_b32_dpp v29, v21, v5 row_newbcast:13 row_mask:0xf bank_mask:0xf
  v_and_b32_dpp v30, v21, v6 row_newbcast:13 row_mask:0xf bank_mask:0xf
  v_and_b32_dpp v31, v21, v7 row_newbcast:13 row_mask:0xf bank_mask:0xf
  s_waitcnt vmcnt(6)
  s_cbranch_vccnz L_m_56
  s_waitcnt vmcnt(4)
L_m_56:
  buffer_load_dwordx4 v[120:123], v10, s[48:51], s8 offen nt
  s_add_u32 s8, s8, 4096
  v_mfma_f32_16x16x32_bf16 v[48:51], v[28:31], v[92:95], v[48:51]
  v_and_b32_dpp v24, v21, v4 row_newbcast:2 row_mask:0xf bank_mask:0xf
  v_and_b32_dpp v25, v21, v5 row_newbcast:2 row_mask:0xf bank_mask:0xf
  v_and_b32_dpp v26, v21, v6 row_newbcast:2 row_mask:0xf bank_mask:0xf
  v_and_b32_dpp v27, v21, v7 row_newbcast:2 row_mask:0xf bank_mask:0xf
  s_waitcnt vmcnt(6)
  s_cbranch_vccnz L_m_57
  s_waitcnt vmcnt(4)
L_m_57:
  buffer_load_dwordx4 v[124:127], v10, s[48:51], s8 offen nt
  s_add_u32 s8, s8, 4096
  v_mfma_f32_16x16x32_bf16 v[48:51], v[24:27], v[96:99], v[48:51]
  v_and_b32_dpp v28, v21, v4 row_newbcast:10 row_mask:0xf bank_mask:0xf
  v_and_b32_dpp v29, v21, v5 row_newbcast:10 row_mask:0xf bank_mask:0xf
  v_and_b32_dpp v30, v21, v6 row_newbcast:10 row_mask:0xf bank_mask:0xf
  v_and_b32_dpp v31, v21, v7 row_newbcast:10 row_mask:0xf bank_mask:0xf
  s_waitcnt vmcnt(6)
  s_nop 0
  v_mfma_f32_16x16x32_bf16 v[48:51], v[28:31], v[100:103], v[48:51]
  v_and_b32_dpp v24, v21, v4 row_newbcast:6 row_mask:0xf bank_mask:0xf
  v_and_b32_dpp v25, v21, v5 row_newbcast:6 row_mask:0xf bank_mask:0xf
  v_and_b32_dpp v26, v21, v6 row_newbcast:6 row_mask:0xf bank_mask:0xf
  v_and_b32_dpp v27, v21, v7 row_newbcast:6 row_mask:0xf bank_mask:0xf
  s_waitcnt vmcnt(5)
  s_nop 0
  v_mfma_f32_16x16x32_bf16 v[48:51], v[24:27], v[104:107], v[48:51]
  v_and_b32_dpp v28, v21, v4 row_newbcast:14 row_mask:0xf bank_mask:0xf
  v_and_b32_dpp v29, v21, v5 row_newbcast:14 row_mask:0xf bank_mask:0xf
  v_and_b32_dpp v30, v21, v6 row_newbcast:14 row_mask:0xf bank_mask:0xf
  v_and_b32_dpp v31, v21, v7 row_newbcast:14 row_mask:0xf bank_mask:0xf
  s_waitcnt vmcnt(4)
  s_nop 0
  v_mfma_f32_16x16x32_bf16 v[48:51], v[28:31], v[108:111], v[48:51]
  v_and_b32_dpp v24, v21, v4 row_newbcast:3 row_mask:0xf bank_mask:0xf
  v_and_b32_dpp v25, v21, v5 row_newbcast:3 row_mask:0xf bank_mask:0xf
  v_and_b32_dpp v26, v21, v6 row_newbcast:3 row_mask:0xf bank_mask:0xf
  v_and_b32_dpp v27, v21, v7 row_newbcast:3 row_mask:0xf bank_mask:0xf
  s_waitcnt vmcnt(3)
  s_nop 0
  v_mfma_f32_16x16x32_bf16 v[48:51], v[24:27], v[112:115], v[48:51]
  v_and_b32_dpp v28, v21, v4 row_newbcast:11 row_mask:0xf bank_mask:0xf
  v_and_b32_dpp v29, v21, v5 row_newbcast:11 row_mask:0xf bank_mask:0xf
  v_and_b32_dpp v30, v21, v6 row_newbcast:11 row_mask:0xf bank_mask:0xf
  v_and_b32_dpp v31, v21, v7 row_newbcast:11 row_mask:0xf bank_mask:0xf
  s_waitcnt vmcnt(2)
  s_nop 0
  v_mfma_f32_16x16x32_bf16 v[48:51], v[28:31], v[116:119], v[48:51]
  v_and_b32_dpp v24, v21, v4 row_newbcast:7 row_mask:0xf bank_mask:0xf
  v_and_b32_dpp v25, v21, v5 row_newbcast:7 row_mask:0xf bank_mask:0xf
  v_and_b32_dpp v26, v21, v6 row_newbcast:7 row_mask:0xf bank_mask:0xf
  v_and_b32_dpp v27, v21, v7 row_newbcast:7 row_mask:0xf bank_mask:0xf
  s_waitcnt vmcnt(1)
  s_nop 0
  v_mfma_f32_16x16x32_bf16 v[48:51], v[24:27], v[120:123], v[48:51]
  v_and_b32_dpp v28, v21, v4 row_newbcast:15 row_mask:0xf bank_mask:0xf
  v_and_b32_dpp v29, v21, v5 row_newbcast:15 row_mask:0xf bank_mask:0xf
  v_and_b32_dpp v30, v21, v6 row_newbcast:15 row_mask:0xf bank_mask:0xf
  v_and_b32_dpp v31, v21, v7 row_newbcast:15 row_mask:0xf bank_mask:0xf
  s_waitcnt vmcnt(0)
  s_nop 0
  v_mfma_f32_16x16x32_bf16 v[48:51], v[28:31], v[124:127], v[48:51]
  s_mov_b32 exec_hi, 0
  s_nop 7
  ds_write_b128 v16, v[48:51]
  s_waitcnt lgkmcnt(0)
  s_barrier
  s_endpgm
L_helper:
  s_sub_u32 s9, s3, 4
  s_waitcnt lgkmcnt(0)
  s_mov_b32 s44, s16
  s_and_b32 s45, s17, 0xffff
  s_mov_b32 s46, 1024
  s_mov_b32 s47, 0x20000
  s_mov_b32 s48, s22
  s_and_b32 s49, s23, 0xffff
  s_mov_b32 s50, 4194304
  s_mov_b32 s51, 0x20000
  v_lshlrev_b32 v16, 4, v0
  buffer_load_dwordx4 v[32:35], v16, s[44:47], 0 offen
  s_mov_b32 s68, 0
  v_add_u32 v46, s68, v1
  v_and_b32 v46, 31, v46
  v_lshlrev_b32 v46, 2, v46
  v_add_u32 v46, v46, v2
  v_add_u32 v80, s68, v1
  v_add_u32 v80, 16, v80
  v_and_b32 v80, 31, v80
  v_lshlrev_b32 v80, 2, v80
  v_add_u32 v80, v80, v2
  v_lshlrev_b32 v17, 2, v1
  v_add_u32 v17, v17, v2
  v_lshlrev_b32 v17, 1, v17
  v_add_u32 v18, 128, v17
  s_lshl_b32 s7, s9, 8
  buffer_load_ushort v44, v17, s[44:47], s7 offen
  buffer_load_ushort v45, v18, s[44:47], s7 offen
  s_lshl_b32 s7, s4, 8
  s_lshl_b32 s8, s9, 20
  s_add_u32 s7, s7, s8
  v_lshlrev_b32 v22, 13, v2
  v_lshlrev_b32 v18, 4, v1
  v_add3_u32 v22, v22, v18, s7
  s_mov_b32 s69, 0
  s_mul_i32 s8, s69, 32768
  buffer_load_dwordx4 v[128:131], v22, s[48:51], s8 offen sc1 nt
  s_add_u32 s69, s69, 1
  s_and_b32 s69, s69, 31
  s_mul_i32 s8, s69, 32768
  s_waitcnt vmcnt(4)
  buffer_load_dwordx4 v[132:135], v22, s[48:51], s8 offen sc1 nt
  s_add_u32 s69, s69, 1
  s_and_b32 s69, s69, 31
  s_mul_i32 s8, s69, 32768
  s_waitcnt vmcnt(4)
  buffer_load_dwordx4 v[136:139], v22, s[48:51], s8 offen sc1 nt
  s_add_u32 s69, s69, 1
  s_and_b32 s69, s69, 31
  s_mul_i32 s8, s69, 32768
  s_waitcnt vmcnt(4)
  buffer_load_dwordx4 v[140:143], v22, s[48:51], s8 offen sc1 nt
  s_add_u32 s69, s69, 1
  s_and_b32 s69, s69, 31
  s_mul_i32 s8, s69, 32768
  s_waitcnt vmcnt(4)
  buffer_load_dwordx4 v[144:147], v22, s[48:51], s8 offen sc1 nt
  s_add_u32 s69, s69, 1
  s_and_b32 s69, s69, 31
  s_mul_i32 s8, s69, 32768
  s_waitcnt vmcnt(4)
  buffer_load_dwordx4 v[148:151], v22, s[48:51], s8 offen sc1 nt
  s_add_u32 s69, s69, 1
  s_and_b32 s69, s69, 31
  s_mul_i32 s8, s69, 32768
  s_waitcnt vmcnt(4)
  buffer_load_dwordx4 v[152:155], v22, s[48:51], s8 offen sc1 nt
  s_add_u32 s69, s69, 1
  s_and_b32 s69, s69, 31
  s_mul_i32 s8, s69, 32768
  s_waitcnt vmcnt(4)
  buffer_load_dwordx4 v[156:159], v22, s[48:51], s8 offen sc1 nt
  s_add_u32 s69, s69, 1
  s_and_b32 s69, s69, 31
  s_mul_i32 s8, s69, 32768
  s_waitcnt vmcnt(4)
  buffer_load_dwordx4 v[160:163], v22, s[48:51], s8 offen sc1 nt
  s_add_u32 s69, s69, 1
  s_and_b32 s69, s69, 31
  s_mul_i32 s8, s69, 32768
  s_waitcnt vmcnt(4)
  buffer_load_dwordx4 v[164:167], v22, s[48:51], s8 offen sc1 nt
  s_add_u32 s69, s69, 1
  s_and_b32 s69, s69, 31
  s_mul_i32 s8, s69, 32768
  s_waitcnt vmcnt(4)
  buffer_load_dwordx4 v[168:171], v22, s[48:51], s8 offen sc1 nt
  s_add_u32 s69, s69, 1
  s_and_b32 s69, s69, 31
  s_mul_i32 s8, s69, 32768
  s_waitcnt vmcnt(4)
  buffer_load_dwordx4 v[172:175], v22, s[48:51], s8 offen sc1 nt
  s_add_u32 s69, s69, 1
  s_and_b32 s69, s69, 31
  s_mul_i32 s8, s69, 32768
  s_waitcnt vmcnt(4)
  buffer_load_dwordx4 v[176:179], v22, s[48:51], s8 offen sc1 nt
  s_add_u32 s69, s69, 1
  s_and_b32 s69, s69, 31
  s_mul_i32 s8, s69, 32768
  s_waitcnt vmcnt(4)
  buffer_load_dwordx4 v[180:183], v22, s[48:51], s8 offen sc1 nt
  s_add_u32 s69, s69, 1
  s_and_b32 s69, s69, 31
  s_mul_i32 s8, s69, 32768
  s_waitcnt vmcnt(4)
  buffer_load_dwordx4 v[184:187], v22, s[48:51], s8 offen sc1 nt
  s_add_u32 s69, s69, 1
  s_and_b32 s69, s69, 31
  s_mul_i32 s8, s69, 32768
  s_waitcnt vmcnt(4)
  buffer_load_dwordx4 v[188:191], v22, s[48:51], s8 offen sc1 nt
  s_add_u32 s69, s69, 1
  s_and_b32 s69, s69, 31
  s_mul_i32 s8, s69, 32768
  s_waitcnt vmcnt(4)
  buffer_load_dwordx4 v[192:195], v22, s[48:51], s8 offen sc1 nt
  s_add_u32 s69, s69, 1
  s_and_b32 s69, s69, 31
  s_mul_i32 s8, s69, 32768
  s_waitcnt vmcnt(4)
  buffer_load_dwordx4 v[196:199], v22, s[48:51], s8 offen sc1 nt
  s_add_u32 s69, s69, 1
  s_and_b32 s69, s69, 31
  s_mul_i32 s8, s69, 32768
  s_waitcnt vmcnt(4)
  buffer_load_dwordx4 v[200:203], v22, s[48:51], s8 offen sc1 nt
  s_add_u32 s69, s69, 1
  s_and_b32 s69, s69, 31
  s_mul_i32 s8, s69, 32768
  s_waitcnt vmcnt(4)
  buffer_load_dwordx4 v[204:207], v22, s[48:51], s8 offen sc1 nt
  s_add_u32 s69, s69, 1
  s_and_b32 s69, s69, 31
  s_mul_i32 s8, s69, 32768
  s_waitcnt vmcnt(4)
  buffer_load_dwordx4 v[208:211], v22, s[48:51], s8 offen sc1 nt
  s_add_u32 s69, s69, 1
  s_and_b32 s69, s69, 31
  s_mul_i32 s8, s69, 32768
  s_waitcnt vmcnt(4)
  buffer_load_dwordx4 v[212:215], v22, s[48:51], s8 offen sc1 nt
  s_add_u32 s69, s69, 1
  s_and_b32 s69, s69, 31
  s_mul_i32 s8, s69, 32768
  s_waitcnt vmcnt(4)
  buffer_load_dwordx4 v[216:219], v22, s[48:51], s8 offen sc1 nt
  s_add_u32 s69, s69, 1
  s_and_b32 s69, s69, 31
  s_mul_i32 s8, s69, 32768
  s_waitcnt vmcnt(4)
  buffer_load_dwordx4 v[220:223], v22, s[48:51], s8 offen sc1 nt
  s_add_u32 s69, s69, 1
  s_and_b32 s69, s69, 31
  s_mul_i32 s8, s69, 32768
  s_waitcnt vmcnt(4)
  buffer_load_dwordx4 v[224:227], v22, s[48:51], s8 offen sc1 nt
  s_add_u32 s69, s69, 1
  s_and_b32 s69, s69, 31
  s_mul_i32 s8, s69, 32768
  s_waitcnt vmcnt(4)
  buffer_load_dwordx4 v[228:231], v22, s[48:51], s8 offen sc1 nt
  s_add_u32 s69, s69, 1
  s_and_b32 s69, s69, 31
  s_mul_i32 s8, s69, 32768
  s_waitcnt vmcnt(4)
  buffer_load_dwordx4 v[232:235], v22, s[48:51], s8 offen sc1 nt
  s_add_u32 s69, s69, 1
  s_and_b32 s69, s69, 31
  s_mul_i32 s8, s69, 32768
  s_waitcnt vmcnt(4)
  buffer_load_dwordx4 v[236:239], v22, s[48:51], s8 offen sc1 nt
  s_add_u32 s69, s69, 1
  s_and_b32 s69, s69, 31
  s_mul_i32 s8, s69, 32768
  s_waitcnt vmcnt(4)
  buffer_load_dwordx4 v[240:243], v22, s[48:51], s8 offen sc1 nt
  s_add_u32 s69, s69, 1
  s_and_b32 s69, s69, 31
  s_mul_i32 s8, s69, 32768
  s_waitcnt vmcnt(4)
  buffer_load_dwordx4 v[244:247], v22, s[48:51], s8 offen sc1 nt
  s_add_u32 s69, s69, 1
  s_and_b32 s69, s69, 31
  s_mul_i32 s8, s69, 32768
  s_waitcnt vmcnt(4)
  buffer_load_dwordx4 v[248:251], v22, s[48:51], s8 offen sc1 nt
  s_add_u32 s69, s69, 1
  s_and_b32 s69, s69, 31
  s_mul_i32 s8, s69, 32768
  s_waitcnt vmcnt(4)
  buffer_load_dwordx4 v[252:255], v22, s[48:51], s8 offen sc1 nt
  s_waitcnt vmcnt(4)
  s_mov_b32 s60, s38
  s_and_b32 s61, s39, 0xffff
  s_mov_b32 s62, 256
  s_mov_b32 s63, 0x20000
  s_mov_b32 s64, s40
  s_and_b32 s65, s41, 0xffff
  s_mov_b32 s66, 622592
  s_mov_b32 s67, 0x20000
  s_mov_b32 s52, s40
  s_and_b32 s53, s41, 0xffff
  s_mov_b32 s54, 622592
  s_mov_b32 s55, 0x20000
  s_cmp_lt_u32 s2, 32
  s_cselect_b32 s54, 622592, 0
  v_mov_b32 v48, -1
  v_mov_b32 v49, -1
  v_mov_b32 v50, -1
  v_mov_b32 v51, -1
  s_lshl_b32 s7, s2, 14
  s_lshl_b32 s8, s9, 12
  s_add_u32 s7, s7, s8
  s_add_u32 s7, s7, 65536
  buffer_store_dwordx4 v[48:51], v16, s[52:55], s7 offen offset:0 sc1
  buffer_store_dwordx4 v[48:51], v16, s[52:55], s7 offen offset:1024 sc1
  buffer_store_dwordx4 v[48:51], v16, s[52:55], s7 offen offset:2048 sc1
  buffer_store_dwordx4 v[48:51], v16, s[52:55], s7 offen offset:3072 sc1
  s_lshl_b32 s7, s2, 11
  s_lshl_b32 s8, s9, 10
  s_add_u32 s7, s7, s8
  s_add_u32 s7, s7, 588800
  s_cmp_lt_u32 s2, 14
  s_cselect_b32 s7, s7, 622592
  s_lshl_b32 s8, s2, 10
  s_add_u32 s8, s8, 32768
  s_cmp_eq_u32 s9, 3
  s_cselect_b32 s7, s8, s7
  s_cmp_eq_u32 s9, 0
  s_cselect_b32 s7, 622592, s7
  buffer_store_dwordx4 v[48:51], v16, s[52:55], s7 offen sc1
  v_mov_b32 v21, 0
  v_lshlrev_b32 v46, 2, v46
  v_lshlrev_b32 v80, 2, v80
  v_lshlrev_b32 v23, 5, v1
  v_and_b32 v17, 1, v2
  v_lshlrev_b32 v17, 4, v17
  v_add_u32 v23, v23, v17
  v_lshlrev_b32 v18, 2, v0
  s_mov_b32 exec_hi, 0
  ds_write_b32 v18, v21 offset:4096
  s_mov_b64 exec, -1
  s_waitcnt vmcnt(39)
  v_lshlrev_b32 v36, 16, v32
  v_and_b32 v37, 0xffff0000, v32
  v_lshlrev_b32 v38, 16, v33
  v_and_b32 v39, 0xffff0000, v33
  v_lshlrev_b32 v40, 16, v34
  v_and_b32 v41, 0xffff0000, v34
  v_lshlrev_b32 v42, 16, v35
  v_and_b32 v43, 0xffff0000, v35
  v_add_f32 v19, v36, v37
  v_add_f32 v19, v19, v38
  v_add_f32 v19, v19, v39
  v_add_f32 v19, v19, v40
  v_add_f32 v19, v19, v41
  v_add_f32 v19, v19, v42
  v_add_f32 v19, v19, v43
  s_nop 1
  v_add_f32_dpp v19, v19, v19 quad_perm:[1,0,3,2] row_mask:0xf bank_mask:0xf
  s_nop 1
  v_add_f32_dpp v19, v19, v19 quad_perm:[2,3,0,1] row_mask:0xf bank_mask:0xf
  s_nop 1
  v_add_f32_dpp v19, v19, v19 row_half_mirror row_mask:0xf bank_mask:0xf
  s_nop 1
  v_add_f32_dpp v19, v19, v19 row_mirror row_mask:0xf bank_mask:0xf
  v_mov_b32 v16, v19
  s_nop 1
  v_permlane16_swap_b32 v19, v16
  s_nop 0
  v_add_f32 v19, v19, v16
  v_mov_b32 v16, v19
  s_nop 1
  v_permlane32_swap_b32 v19, v16
  s_nop 0
  v_add_f32 v19, v19, v16
  v_mul_f32 v19, 0x3b000000, v19
  v_sub_f32 v36, v36, v19
  v_sub_f32 v37, v37, v19
  v_sub_f32 v38, v38, v19
  v_sub_f32 v39, v39, v19
  v_sub_f32 v40, v40, v19
  v_sub_f32 v41, v41, v19
  v_sub_f32 v42, v42, v19
  v_sub_f32 v43, v43, v19
  v_mul_f32 v20, v36, v36
  v_fmac_f32 v20, v37, v37
  v_fmac_f32 v20, v38, v38
  v_fmac_f32 v20, v39, v39
  v_fmac_f32 v20, v40, v40
  v_fmac_f32 v20, v41, v41
  v_fmac_f32 v20, v42, v42
  v_fmac_f32 v20, v43, v43
  s_nop 1
  v_add_f32_dpp v20, v20, v20 quad_perm:[1,0,3,2] row_mask:0xf bank_mask:0xf
  s_nop 1
  v_add_f32_dpp v20, v20, v20 quad_perm:[2,3,0,1] row_mask:0xf bank_mask:0xf
  s_nop 1
  v_add_f32_dpp v20, v20, v20 row_half_mirror row_mask:0xf bank_mask:0xf
  s_nop 1
  v_add_f32_dpp v20, v20, v20 row_mirror row_mask:0xf bank_mask:0xf
  v_mov_b32 v16, v20
  s_nop 1
  v_permlane16_swap_b32 v20, v16
  s_nop 0
  v_add_f32 v20, v20, v16
  v_mov_b32 v16, v20
  s_nop 1
  v_permlane32_swap_b32 v20, v16
  s_nop 0
  v_add_f32 v20, v20, v16
  v_mul_f32 v20, 0x3b000000, v20
  v_cvt_pk_bf16_f32 v19, v19, v19
  v_and_b32 v19, 0xffff0000, v19
  v_cvt_pk_bf16_f32 v20, v20, v20
  v_and_b32 v20, 0xffff0000, v20
  v_add_f32 v20, 0x3727c5ac, v20
  v_cvt_pk_bf16_f32 v20, v20, v20
  v_and_b32 v20, 0xffff0000, v20
  v_sqrt_f32 v20, v20
  s_nop 0
  v_cvt_pk_bf16_f32 v20, v20, v20
  v_and_b32 v20, 0xffff0000, v20
  v_rcp_f32 v20, v20
  s_waitcnt vmcnt(37)
  v_lshlrev_b32 v44, 16, v44
  v_sub_f32 v44, v44, v19
  v_cvt_pk_bf16_f32 v44, v44, v44
  v_and_b32 v44, 0xffff0000, v44
  v_mul_f32 v44, v44, v20
  v_cvt_pk_bf16_f32 v44, v44, v44
  v_lshlrev_b32 v45, 16, v45
  v_sub_f32 v45, v45, v19
  v_cvt_pk_bf16_f32 v45, v45, v45
  v_and_b32 v45, 0xffff0000, v45
  v_mul_f32 v45, v45, v20
  v_cvt_pk_bf16_f32 v45, v45, v45
  s_nop 1
  v_and_b32_dpp v24, v44, v4 row_newbcast:0 row_mask:0xf bank_mask:0xf
  v_and_b32_dpp v25, v44, v5 row_newbcast:0 row_mask:0xf bank_mask:0xf
  v_and_b32_dpp v26, v44, v6 row_newbcast:0 row_mask:0xf bank_mask:0xf
  v_and_b32_dpp v27, v44, v7 row_newbcast:0 row_mask:0xf bank_mask:0xf
  v_and_b32_dpp v28, v44, v4 row_newbcast:1 row_mask:0xf bank_mask:0xf
  v_and_b32_dpp v29, v44, v5 row_newbcast:1 row_mask:0xf bank_mask:0xf
  v_and_b32_dpp v30, v44, v6 row_newbcast:1 row_mask:0xf bank_mask:0xf
  v_and_b32_dpp v31, v44, v7 row_newbcast:1 row_mask:0xf bank_mask:0xf
  s_waitcnt vmcnt(36)
  v_mfma_f32_16x16x32_bf16 v[52:55], v[24:27], v[128:131], 0
  v_and_b32_dpp v24, v44, v4 row_newbcast:2 row_mask:0xf bank_mask:0xf
  v_and_b32_dpp v25, v44, v5 row_newbcast:2 row_mask:0xf bank_mask:0xf
  v_and_b32_dpp v26, v44, v6 row_newbcast:2 row_mask:0xf bank_mask:0xf
  v_and_b32_dpp v27, v44, v7 row_newbcast:2 row_mask:0xf bank_mask:0xf
  s_waitcnt vmcnt(35)
  v_mfma_f32_16x16x32_bf16 v[52:55], v[28:31], v[132:135], v[52:55]
  v_and_b32_dpp v28, v44, v4 row_newbcast:3 row_mask:0xf bank_mask:0xf
  v_and_b32_dpp v29, v44, v5 row_newbcast:3 row_mask:0xf bank_mask:0xf
  v_and_b32_dpp v30, v44, v6 row_newbcast:3 row_mask:0xf bank_mask:0xf
  v_and_b32_dpp v31, v44, v7 row_newbcast:3 row_mask:0xf bank_mask:0xf
  s_waitcnt vmcnt(34)
  v_mfma_f32_16x16x32_bf16 v[52:55], v[24:27], v[136:139], v[52:55]
  v_and_b32_dpp v24, v44, v4 row_newbcast:4 row_mask:0xf bank_mask:0xf
  v_and_b32_dpp v25, v44, v5 row_newbcast:4 row_mask:0xf bank_mask:0xf
  v_and_b32_dpp v26, v44, v6 row_newbcast:4 row_mask:0xf bank_mask:0xf
  v_and_b32_dpp v27, v44, v7 row_newbcast:4 row_mask:0xf bank_mask:0xf
  s_waitcnt vmcnt(33)
  v_mfma_f32_16x16x32_bf16 v[52:55], v[28:31], v[140:143], v[52:55]
  v_and_b32_dpp v28, v44, v4 row_newbcast:5 row_mask:0xf bank_mask:0xf
  v_and_b32_dpp v29, v44, v5 row_newbcast:5 row_mask:0xf bank_mask:0xf
  v_and_b32_dpp v30, v44, v6 row_newbcast:5 row_mask:0xf bank_mask:0xf
  v_and_b32_dpp v31, v44, v7 row_newbcast:5 row_mask:0xf bank_mask:0xf
  s_waitcnt vmcnt(32)
  v_mfma_f32_16x16x32_bf16 v[52:55], v[24:27], v[144:147], v[52:55]
  v_and_b32_dpp v24, v44, v4 row_newbcast:6 row_mask:0xf bank_mask:0xf
  v_and_b32_dpp v25, v44, v5 row_newbcast:6 row_mask:0xf bank_mask:0xf
  v_and_b32_dpp v26, v44, v6 row_newbcast:6 row_mask:0xf bank_mask:0xf
  v_and_b32_dpp v27, v44, v7 row_newbcast:6 row_mask:0xf bank_mask:0xf
  s_waitcnt vmcnt(31)
  v_mfma_f32_16x16x32_bf16 v[52:55], v[28:31], v[148:151], v[52:55]
  v_and_b32_dpp v28, v44, v4 row_newbcast:7 row_mask:0xf bank_mask:0xf
  v_and_b32_dpp v29, v44, v5 row_newbcast:7 row_mask:0xf bank_mask:0xf
  v_and_b32_dpp v30, v44, v6 row_newbcast:7 row_mask:0xf bank_mask:0xf
  v_and_b32_dpp v31, v44, v7 row_newbcast:7 row_mask:0xf bank_mask:0xf
  s_waitcnt vmcnt(30)
  v_mfma_f32_16x16x32_bf16 v[52:55], v[24:27], v[152:155], v[52:55]
  v_and_b32_dpp v24, v44, v4 row_newbcast:8 row_mask:0xf bank_mask:0xf
  v_and_b32_dpp v25, v44, v5 row_newbcast:8 row_mask:0xf bank_mask:0xf
  v_and_b32_dpp v26, v44, v6 row_newbcast:8 row_mask:0xf bank_mask:0xf
  v_and_b32_dpp v27, v44, v7 row_newbcast:8 row_mask:0xf bank_mask:0xf
  s_waitcnt vmcnt(29)
  v_mfma_f32_16x16x32_bf16 v[52:55], v[28:31], v[156:159], v[52:55]
  v_and_b32_dpp v28, v44, v4 row_newbcast:9 row_mask:0xf bank_mask:0xf
  v_and_b32_dpp v29, v44, v5 row_newbcast:9 row_mask:0xf bank_mask:0xf
  v_and_b32_dpp v30, v44, v6 row_newbcast:9 row_mask:0xf bank_mask:0xf
  v_and_b32_dpp v31, v44, v7 row_newbcast:9 row_mask:0xf bank_mask:0xf
  s_waitcnt vmcnt(28)
  v_mfma_f32_16x16x32_bf16 v[52:55], v[24:27], v[160:163], v[52:55]
  v_and_b32_dpp v24, v44, v4 row_newbcast:10 row_mask:0xf bank_mask:0xf
  v_and_b32_dpp v25, v44, v5 row_newbcast:10 row_mask:0xf bank_mask:0xf
  v_and_b32_dpp v26, v44, v6 row_newbcast:10 row_mask:0xf bank_mask:0xf
  v_and_b32_dpp v27, v44, v7 row_newbcast:10 row_mask:0xf bank_mask:0xf
  s_waitcnt vmcnt(27)
  v_mfma_f32_16x16x32_bf16 v[52:55], v[28:31], v[164:167], v[52:55]
  v_and_b32_dpp v28, v44, v4 row_newbcast:11 row_mask:0xf bank_mask:0xf
  v_and_b32_dpp v29, v44, v5 row_newbcast:11 row_mask:0xf bank_mask:0xf
  v_and_b32_dpp v30, v44, v6 row_newbcast:11 row_mask:0xf bank_mask:0xf
  v_and_b32_dpp v31, v44, v7 row_newbcast:11 row_mask:0xf bank_mask:0xf
  s_waitcnt vmcnt(26)
  v_mfma_f32_16x16x32_bf16 v[52:55], v[24:27], v[168:171], v[52:55]
  v_and_b32_dpp v24, v44, v4 row_newbcast:12 row_mask:0xf bank_mask:0xf
  v_and_b32_dpp v25, v44, v5 row_newbcast:12 row_mask:0xf bank_mask:0xf
  v_and_b32_dpp v26, v44, v6 row_newbcast:12 row_mask:0xf bank_mask:0xf
  v_and_b32_dpp v27, v44, v7 row_newbcast:12 row_mask:0xf bank_mask:0xf
  s_waitcnt vmcnt(25)
  v_mfma_f32_16x16x32_bf16 v[52:55], v[28:31], v[172:175], v[52:55]
  v_and_b32_dpp v28, v44, v4 row_newbcast:13 row_mask:0xf bank_mask:0xf
  v_and_b32_dpp v29, v44, v5 row_newbcast:13 row_mask:0xf bank_mask:0xf
  v_and_b32_dpp v30, v44, v6 row_newbcast:13 row_mask:0xf bank_mask:0xf
  v_and_b32_dpp v31, v44, v7 row_newbcast:13 row_mask:0xf bank_mask:0xf
  s_waitcnt vmcnt(24)
  v_mfma_f32_16x16x32_bf16 v[52:55], v[24:27], v[176:179], v[52:55]
  v_and_b32_dpp v24, v44, v4 row_newbcast:14 row_mask:0xf bank_mask:0xf
  v_and_b32_dpp v25, v44, v5 row_newbcast:14 row_mask:0xf bank_mask:0xf
  v_and_b32_dpp v26, v44, v6 row_newbcast:14 row_mask:0xf bank_mask:0xf
  v_and_b32_dpp v27, v44, v7 row_newbcast:14 row_mask:0xf bank_mask:0xf
  s_waitcnt vmcnt(23)
  v_mfma_f32_16x16x32_bf16 v[52:55], v[28:31], v[180:183], v[52:55]
  v_and_b32_dpp v28, v44, v4 row_newbcast:15 row_mask:0xf bank_mask:0xf
  v_and_b32_dpp v29, v44, v5 row_newbcast:15 row_mask:0xf bank_mask:0xf
  v_and_b32_dpp v30, v44, v6 row_newbcast:15 row_mask:0xf bank_mask:0xf
  v_and_b32_dpp v31, v44, v7 row_newbcast:15 row_mask:0xf bank_mask:0xf
  s_waitcnt vmcnt(22)
  v_mfma_f32_16x16x32_bf16 v[52:55], v[24:27], v[184:187], v[52:55]
  v_and_b32_dpp v24, v45, v4 row_newbcast:0 row_mask:0xf bank_mask:0xf
  v_and_b32_dpp v25, v45, v5 row_newbcast:0 row_mask:0xf bank_mask:0xf
  v_and_b32_dpp v26, v45, v6 row_newbcast:0 row_mask:0xf bank_mask:0xf
  v_and_b32_dpp v27, v45, v7 row_newbcast:0 row_mask:0xf bank_mask:0xf
  s_waitcnt vmcnt(21)
  v_mfma_f32_16x16x32_bf16 v[52:55], v[28:31], v[188:191], v[52:55]
  v_and_b32_dpp v28, v45, v4 row_newbcast:1 row_mask:0xf bank_mask:0xf
  v_and_b32_dpp v29, v45, v5 row_newbcast:1 row_mask:0xf bank_mask:0xf
  v_and_b32_dpp v30, v45, v6 row_newbcast:1 row_mask:0xf bank_mask:0xf
  v_and_b32_dpp v31, v45, v7 row_newbcast:1 row_mask:0xf bank_mask:0xf
  s_waitcnt vmcnt(20)
  v_mfma_f32_16x16x32_bf16 v[52:55], v[24:27], v[192:195], v[52:55]
  v_and_b32_dpp v24, v45, v4 row_newbcast:2 row_mask:0xf bank_mask:0xf
  v_and_b32_dpp v25, v45, v5 row_newbcast:2 row_mask:0xf bank_mask:0xf
  v_and_b32_dpp v26, v45, v6 row_newbcast:2 row_mask:0xf bank_mask:0xf
  v_and_b32_dpp v27, v45, v7 row_newbcast:2 row_mask:0xf bank_mask:0xf
  s_waitcnt vmcnt(19)
  v_mfma_f32_16x16x32_bf16 v[52:55], v[28:31], v[196:199], v[52:55]
  v_and_b32_dpp v28, v45, v4 row_newbcast:3 row_mask:0xf bank_mask:0xf
  v_and_b32_dpp v29, v45, v5 row_newbcast:3 row_mask:0xf bank_mask:0xf
  v_and_b32_dpp v30, v45, v6 row_newbcast:3 row_mask:0xf bank_mask:0xf
  v_and_b32_dpp v31, v45, v7 row_newbcast:3 row_mask:0xf bank_mask:0xf
  s_waitcnt vmcnt(18)
  v_mfma_f32_16x16x32_bf16 v[52:55], v[24:27], v[200:203], v[52:55]
  v_and_b32_dpp v24, v45, v4 row_newbcast:4 row_mask:0xf bank_mask:0xf
  v_and_b32_dpp v25, v45, v5 row_newbcast:4 row_mask:0xf bank_mask:0xf
  v_and_b32_dpp v26, v45, v6 row_newbcast:4 row_mask:0xf bank_mask:0xf
  v_and_b32_dpp v27, v45, v7 row_newbcast:4 row_mask:0xf bank_mask:0xf
  s_waitcnt vmcnt(17)
  v_mfma_f32_16x16x32_bf16 v[52:55], v[28:31], v[204:207], v[52:55]
  v_and_b32_dpp v28, v45, v4 row_newbcast:5 row_mask:0xf bank_mask:0xf
  v_and_b32_dpp v29, v45, v5 row_newbcast:5 row_mask:0xf bank_mask:0xf
  v_and_b32_dpp v30, v45, v6 row_newbcast:5 row_mask:0xf bank_mask:0xf
  v_and_b32_dpp v31, v45, v7 row_newbcast:5 row_mask:0xf bank_mask:0xf
  s_waitcnt vmcnt(16)
  v_mfma_f32_16x16x32_bf16 v[52:55], v[24:27], v[208:211], v[52:55]
  v_and_b32_dpp v24, v45, v4 row_newbcast:6 row_mask:0xf bank_mask:0xf
  v_and_b32_dpp v25, v45, v5 row_newbcast:6 row_mask:0xf bank_mask:0xf
  v_and_b32_dpp v26, v45, v6 row_newbcast:6 row_mask:0xf bank_mask:0xf
  v_and_b32_dpp v27, v45, v7 row_newbcast:6 row_mask:0xf bank_mask:0xf
  s_waitcnt vmcnt(15)
  v_mfma_f32_16x16x32_bf16 v[52:55], v[28:31], v[212:215], v[52:55]
  v_and_b32_dpp v28, v45, v4 row_newbcast:7 row_mask:0xf bank_mask:0xf
  v_and_b32_dpp v29, v45, v5 row_newbcast:7 row_mask:0xf bank_mask:0xf
  v_and_b32_dpp v30, v45, v6 row_newbcast:7 row_mask:0xf bank_mask:0xf
  v_and_b32_dpp v31, v45, v7 row_newbcast:7 row_mask:0xf bank_mask:0xf
  s_waitcnt vmcnt(14)
  v_mfma_f32_16x16x32_bf16 v[52:55], v[24:27], v[216:219], v[52:55]
  v_and_b32_dpp v24, v45, v4 row_newbcast:8 row_mask:0xf bank_mask:0xf
  v_and_b32_dpp v25, v45, v5 row_newbcast:8 row_mask:0xf bank_mask:0xf
  v_and_b32_dpp v26, v45, v6 row_newbcast:8 row_mask:0xf bank_mask:0xf
  v_and_b32_dpp v27, v45, v7 row_newbcast:8 row_mask:0xf bank_mask:0xf
  s_waitcnt vmcnt(13)
  v_mfma_f32_16x16x32_bf16 v[52:55], v[28:31], v[220:223], v[52:55]
  v_and_b32_dpp v28, v45, v4 row_newbcast:9 row_mask:0xf bank_mask:0xf
  v_and_b32_dpp v29, v45, v5 row_newbcast:9 row_mask:0xf bank_mask:0xf
  v_and_b32_dpp v30, v45, v6 row_newbcast:9 row_mask:0xf bank_mask:0xf
  v_and_b32_dpp v31, v45, v7 row_newbcast:9 row_mask:0xf bank_mask:0xf
  s_waitcnt vmcnt(12)
  v_mfma_f32_16x16x32_bf16 v[52:55], v[24:27], v[224:227], v[52:55]
  v_and_b32_dpp v24, v45, v4 row_newbcast:10 row_mask:0xf bank_mask:0xf
  v_and_b32_dpp v25, v45, v5 row_newbcast:10 row_mask:0xf bank_mask:0xf
  v_and_b32_dpp v26, v45, v6 row_newbcast:10 row_mask:0xf bank_mask:0xf
  v_and_b32_dpp v27, v45, v7 row_newbcast:10 row_mask:0xf bank_mask:0xf
  s_waitcnt vmcnt(11)
  v_mfma_f32_16x16x32_bf16 v[52:55], v[28:31], v[228:231], v[52:55]
  v_and_b32_dpp v28, v45, v4 row_newbcast:11 row_mask:0xf bank_mask:0xf
  v_and_b32_dpp v29, v45, v5 row_newbcast:11 row_mask:0xf bank_mask:0xf
  v_and_b32_dpp v30, v45, v6 row_newbcast:11 row_mask:0xf bank_mask:0xf
  v_and_b32_dpp v31, v45, v7 row_newbcast:11 row_mask:0xf bank_mask:0xf
  s_waitcnt vmcnt(10)
  v_mfma_f32_16x16x32_bf16 v[52:55], v[24:27], v[232:235], v[52:55]
  v_and_b32_dpp v24, v45, v4 row_newbcast:12 row_mask:0xf bank_mask:0xf
  v_and_b32_dpp v25, v45, v5 row_newbcast:12 row_mask:0xf bank_mask:0xf
  v_and_b32_dpp v26, v45, v6 row_newbcast:12 row_mask:0xf bank_mask:0xf
  v_and_b32_dpp v27, v45, v7 row_newbcast:12 row_mask:0xf bank_mask:0xf
  s_waitcnt vmcnt(9)
  v_mfma_f32_16x16x32_bf16 v[52:55], v[28:31], v[236:239], v[52:55]
  v_and_b32_dpp v28, v45, v4 row_newbcast:13 row_mask:0xf bank_mask:0xf
  v_and_b32_dpp v29, v45, v5 row_newbcast:13 row_mask:0xf bank_mask:0xf
  v_and_b32_dpp v30, v45, v6 row_newbcast:13 row_mask:0xf bank_mask:0xf
  v_and_b32_dpp v31, v45, v7 row_newbcast:13 row_mask:0xf bank_mask:0xf
  s_waitcnt vmcnt(8)
  v_mfma_f32_16x16x32_bf16 v[52:55], v[24:27], v[240:243], v[52:55]
  v_and_b32_dpp v24, v45, v4 row_newbcast:14 row_mask:0xf bank_mask:0xf
  v_and_b32_dpp v25, v45, v5 row_newbcast:14 row_mask:0xf bank_mask:0xf
  v_and_b32_dpp v26, v45, v6 row_newbcast:14 row_mask:0xf bank_mask:0xf
  v_and_b32_dpp v27, v45, v7 row_newbcast:14 row_mask:0xf bank_mask:0xf
  s_waitcnt vmcnt(7)
  v_mfma_f32_16x16x32_bf16 v[52:55], v[28:31], v[244:247], v[52:55]
  v_and_b32_dpp v28, v45, v4 row_newbcast:15 row_mask:0xf bank_mask:0xf
  v_and_b32_dpp v29, v45, v5 row_newbcast:15 row_mask:0xf bank_mask:0xf
  v_and_b32_dpp v30, v45, v6 row_newbcast:15 row_mask:0xf bank_mask:0xf
  v_and_b32_dpp v31, v45, v7 row_newbcast:15 row_mask:0xf bank_mask:0xf
  s_waitcnt vmcnt(6)
  v_mfma_f32_16x16x32_bf16 v[52:55], v[24:27], v[248:251], v[52:55]
  s_nop 1
  s_waitcnt vmcnt(5)
  v_mfma_f32_16x16x32_bf16 v[52:55], v[28:31], v[252:255], v[52:55]
  s_lshl_b32 s7, s9, 9
  v_add_u32 v16, s7, v23
  s_mov_b32 exec_hi, 0
  s_nop 5
  ds_write_b128 v16, v[52:55] offset:0
  s_mov_b32 exec_hi, -1
  s_waitcnt vmcnt(0) lgkmcnt(0)
  s_barrier
  s_cmp_ge_u32 s2, 32
  s_cbranch_scc1 L_noflag_58
  s_cmp_lg_u32 s9, 0
  s_cbranch_scc1 L_noflag_58
  v_mov_b32 v17, 1
  s_lshl_b32 s7, s2, 2
  s_mov_b64 exec, 1
  buffer_store_dword v17, v21, s[60:63], s7 offen sc1
  s_mov_b64 exec, -1
L_noflag_58:
  s_sub_u32 s10, s2, 32
  s_cmp_ge_u32 s10, 14
  s_cbranch_scc1 L_noffn_59
  s_mov_b32 s48, s28
  s_and_b32 s49, s29, 0xffff
  s_mov_b32 s50, 1835008
  s_mov_b32 s51, 0x20000
  s_mov_b32 s52, s30
  s_and_b32 s53, s31, 0xffff
  s_mov_b32 s54, 3584
  s_mov_b32 s55, 0x20000
  s_mov_b32 s56, s32
  s_and_b32 s57, s33, 0xffff
  s_mov_b32 s58, 1835008
  s_mov_b32 s59, 0x20000
  s_lshl_b32 s7, s10, 8
  v_lshrrev_b32 v16, 1, v46
  v_lshrrev_b32 v17, 1, v80
  buffer_load_ushort v72, v16, s[52:55], s7 offen
  buffer_load_ushort v73, v17, s[52:55], s7 offen
  s_mul_i32 s8, s9, 458752
  s_add_u32 s7, s7, s8
  v_mul_u32_u24 v22, 3584, v2
  v_lshlrev_b32 v18, 4, v1
  v_add3_u32 v22, v22, v18, s7
  s_mov_b32 s69, 0
  s_mul_i32 s8, s69, 14336
  buffer_load_dwordx4 v[128:131], v22, s[48:51], s8 offen sc1 nt
  s_add_u32 s69, s69, 1
  s_and_b32 s69, s69, 31
  s_mul_i32 s8, s69, 14336
  s_waitcnt vmcnt(1)
  buffer_load_dwordx4 v[132:135], v22, s[48:51], s8 offen sc1 nt
  s_add_u32 s69, s69, 1
  s_and_b32 s69, s69, 31
  s_mul_i32 s8, s69, 14336
  s_waitcnt vmcnt(1)
  buffer_load_dwordx4 v[136:139], v22, s[48:51], s8 offen sc1 nt
  s_add_u32 s69, s69, 1
  s_and_b32 s69, s69, 31
  s_mul_i32 s8, s69, 14336
  s_waitcnt vmcnt(1)
  buffer_load_dwordx4 v[140:143], v22, s[48:51], s8 offen sc1 nt
  s_add_u32 s69, s69, 1
  s_and_b32 s69, s69, 31
  s_mul_i32 s8, s69, 14336
  s_waitcnt vmcnt(1)
  buffer_load_dwordx4 v[144:147], v22, s[48:51], s8 offen sc1 nt
  s_add_u32 s69, s69, 1
  s_and_b32 s69, s69, 31
  s_mul_i32 s8, s69, 14336
  s_waitcnt vmcnt(1)
  buffer_load_dwordx4 v[148:151], v22, s[48:51], s8 offen sc1 nt
  s_add_u32 s69, s69, 1
  s_and_b32 s69, s69, 31
  s_mul_i32 s8, s69, 14336
  s_waitcnt vmcnt(1)
  buffer_load_dwordx4 v[152:155], v22, s[48:51], s8 offen sc1 nt
  s_add_u32 s69, s69, 1
  s_and_b32 s69, s69, 31
  s_mul_i32 s8, s69, 14336
  s_waitcnt vmcnt(1)
  buffer_load_dwordx4 v[156:159], v22, s[48:51], s8 offen sc1 nt
  s_add_u32 s69, s69, 1
  s_and_b32 s69, s69, 31
  s_mul_i32 s8, s69, 14336
  s_waitcnt vmcnt(1)
  buffer_load_dwordx4 v[160:163], v22, s[48:51], s8 offen sc1 nt
  s_add_u32 s69, s69, 1
  s_and_b32 s69, s69, 31
  s_mul_i32 s8, s69, 14336
  s_waitcnt vmcnt(1)
  buffer_load_dwordx4 v[164:167], v22, s[48:51], s8 offen sc1 nt
  s_add_u32 s69, s69, 1
  s_and_b32 s69, s69, 31
  s_mul_i32 s8, s69, 14336
  s_waitcnt vmcnt(1)
  buffer_load_dwordx4 v[168:171], v22, s[48:51], s8 offen sc1 nt
  s_add_u32 s69, s69, 1
  s_and_b32 s69, s69, 31
  s_mul_i32 s8, s69, 14336
  s_waitcnt vmcnt(1)
  buffer_load_dwordx4 v[172:175], v22, s[48:51], s8 offen sc1 nt
  s_add_u32 s69, s69, 1
  s_and_b32 s69, s69, 31
  s_mul_i32 s8, s69, 14336
  s_waitcnt vmcnt(1)
  buffer_load_dwordx4 v[176:179], v22, s[48:51], s8 offen sc1 nt
  s_add_u32 s69, s69, 1
  s_and_b32 s69, s69, 31
  s_mul_i32 s8, s69, 14336
  s_waitcnt vmcnt(1)
  buffer_load_dwordx4 v[180:183], v22, s[48:51], s8 offen sc1 nt
  s_add_u32 s69, s69, 1
  s_and_b32 s69, s69, 31
  s_mul_i32 s8, s69, 14336
  s_waitcnt vmcnt(1)
  buffer_load_dwordx4 v[184:187], v22, s[48:51], s8 offen sc1 nt
  s_add_u32 s69, s69, 1
  s_and_b32 s69, s69, 31
  s_mul_i32 s8, s69, 14336
  s_waitcnt vmcnt(1)
  buffer_load_dwordx4 v[188:191], v22, s[48:51], s8 offen sc1 nt
  s_add_u32 s69, s69, 1
  s_and_b32 s69, s69, 31
  s_mul_i32 s8, s69, 14336
  s_waitcnt vmcnt(1)
  buffer_load_dwordx4 v[192:195], v22, s[48:51], s8 offen sc1 nt
  s_add_u32 s69, s69, 1
  s_and_b32 s69, s69, 31
  s_mul_i32 s8, s69, 14336
  s_waitcnt vmcnt(1)
  buffer_load_dwordx4 v[196:199], v22, s[48:51], s8 offen sc1 nt
  s_add_u32 s69, s69, 1
  s_and_b32 s69, s69, 31
  s_mul_i32 s8, s69, 14336
  s_waitcnt vmcnt(1)
  buffer_load_dwordx4 v[200:203], v22, s[48:51], s8 offen sc1 nt
  s_add_u32 s69, s69, 1
  s_and_b32 s69, s69, 31
  s_mul_i32 s8, s69, 14336
  s_waitcnt vmcnt(1)
  buffer_load_dwordx4 v[204:207], v22, s[48:51], s8 offen sc1 nt
  s_add_u32 s69, s69, 1
  s_and_b32 s69, s69, 31
  s_mul_i32 s8, s69, 14336
  s_waitcnt vmcnt(1)
  buffer_load_dwordx4 v[208:211], v22, s[48:51], s8 offen sc1 nt
  s_add_u32 s69, s69, 1
  s_and_b32 s69, s69, 31
  s_mul_i32 s8, s69, 14336
  s_waitcnt vmcnt(1)
  buffer_load_dwordx4 v[212:215], v22, s[48:51], s8 offen sc1 nt
  s_add_u32 s69, s69, 1
  s_and_b32 s69, s69, 31
  s_mul_i32 s8, s69, 14336
  s_waitcnt vmcnt(1)
  buffer_load_dwordx4 v[216:219], v22, s[48:51], s8 offen sc1 nt
  s_add_u32 s69, s69, 1
  s_and_b32 s69, s69, 31
  s_mul_i32 s8, s69, 14336
  s_waitcnt vmcnt(1)
  buffer_load_dwordx4 v[220:223], v22, s[48:51], s8 offen sc1 nt
  s_add_u32 s69, s69, 1
  s_and_b32 s69, s69, 31
  s_mul_i32 s8, s69, 14336
  s_waitcnt vmcnt(1)
  buffer_load_dwordx4 v[224:227], v22, s[48:51], s8 offen sc1 nt
  s_add_u32 s69, s69, 1
  s_and_b32 s69, s69, 31
  s_mul_i32 s8, s69, 14336
  s_waitcnt vmcnt(1)
  buffer_load_dwordx4 v[228:231], v22, s[48:51], s8 offen sc1 nt
  s_add_u32 s69, s69, 1
  s_and_b32 s69, s69, 31
  s_mul_i32 s8, s69, 14336
  s_waitcnt vmcnt(1)
  buffer_load_dwordx4 v[232:235], v22, s[48:51], s8 offen sc1 nt
  s_add_u32 s69, s69, 1
  s_and_b32 s69, s69, 31
  s_mul_i32 s8, s69, 14336
  s_waitcnt vmcnt(1)
  buffer_load_dwordx4 v[236:239], v22, s[48:51], s8 offen sc1 nt
  s_add_u32 s69, s69, 1
  s_and_b32 s69, s69, 31
  s_mul_i32 s8, s69, 14336
  s_waitcnt vmcnt(1)
  buffer_load_dwordx4 v[240:243], v22, s[48:51], s8 offen sc1 nt
  s_add_u32 s69, s69, 1
  s_and_b32 s69, s69, 31
  s_mul_i32 s8, s69, 14336
  s_waitcnt vmcnt(1)
  buffer_load_dwordx4 v[244:247], v22, s[48:51], s8 offen sc1 nt
  s_add_u32 s69, s69, 1
  s_and_b32 s69, s69, 31
  s_mul_i32 s8, s69, 14336
  s_waitcnt vmcnt(1)
  buffer_load_dwordx4 v[248:251], v22, s[48:51], s8 offen sc1 nt
  s_add_u32 s69, s69, 1
  s_and_b32 s69, s69, 31
  s_mul_i32 s8, s69, 14336
  s_waitcnt vmcnt(1)
  buffer_load_dwordx4 v[252:255], v22, s[48:51], s8 offen sc1 nt
  s_waitcnt vmcnt(1)
  v_and_b32_dpp v24, v44, v4 row_newbcast:0 row_mask:0xf bank_mask:0xf
  v_and_b32_dpp v25, v44, v5 row_newbcast:0 row_mask:0xf bank_mask:0xf
  v_and_b32_dpp v26, v44, v6 row_newbcast:0 row_mask:0xf bank_mask:0xf
  v_and_b32_dpp v27, v44, v7 row_newbcast:0 row_mask:0xf bank_mask:0xf
  v_and_b32_dpp v28, v44, v4 row_newbcast:1 row_mask:0xf bank_mask:0xf
  v_and_b32_dpp v29, v44, v5 row_newbcast:1 row_mask:0xf bank_mask:0xf
  v_and_b32_dpp v30, v44, v6 row_newbcast:1 row_mask:0xf bank_mask:0xf
  v_and_b32_dpp v31, v44, v7 row_newbcast:1 row_mask:0xf bank_mask:0xf
  s_waitcnt vmcnt(31)
  v_mfma_f32_16x16x32_bf16 v[52:55], v[24:27], v[128:131], 0
  v_and_b32_dpp v24, v44, v4 row_newbcast:2 row_mask:0xf bank_mask:0xf
  v_and_b32_dpp v25, v44, v5 row_newbcast:2 row_mask:0xf bank_mask:0xf
  v_and_b32_dpp v26, v44, v6 row_newbcast:2 row_mask:0xf bank_mask:0xf
  v_and_b32_dpp v27, v44, v7 row_newbcast:2 row_mask:0xf bank_mask:0xf
  s_waitcnt vmcnt(30)
  v_mfma_f32_16x16x32_bf16 v[52:55], v[28:31], v[132:135], v[52:55]
  v_and_b32_dpp v28, v44, v4 row_newbcast:3 row_mask:0xf bank_mask:0xf
  v_and_b32_dpp v29, v44, v5 row_newbcast:3 row_mask:0xf bank_mask:0xf
  v_and_b32_dpp v30, v44, v6 row_newbcast:3 row_mask:0xf bank_mask:0xf
  v_and_b32_dpp v31, v44, v7 row_newbcast:3 row_mask:0xf bank_mask:0xf
  s_waitcnt vmcnt(29)
  v_mfma_f32_16x16x32_bf16 v[52:55], v[24:27], v[136:139], v[52:55]
  v_and_b32_dpp v24, v44, v4 row_newbcast:4 row_mask:0xf bank_mask:0xf
  v_and_b32_dpp v25, v44, v5 row_newbcast:4 row_mask:0xf bank_mask:0xf
  v_and_b32_dpp v26, v44, v6 row_newbcast:4 row_mask:0xf bank_mask:0xf
  v_and_b32_dpp v27, v44, v7 row_newbcast:4 row_mask:0xf bank_mask:0xf
  s_waitcnt vmcnt(28)
  v_mfma_f32_16x16x32_bf16 v[52:55], v[28:31], v[140:143], v[52:55]
  v_and_b32_dpp v28, v44, v4 row_newbcast:5 row_mask:0xf bank_mask:0xf
  v_and_b32_dpp v29, v44, v5 row_newbcast:5 row_mask:0xf bank_mask:0xf
  v_and_b32_dpp v30, v44, v6 row_newbcast:5 row_mask:0xf bank_mask:0xf
  v_and_b32_dpp v31, v44, v7 row_newbcast:5 row_mask:0xf bank_mask:0xf
  s_waitcnt vmcnt(27)
  v_mfma_f32_16x16x32_bf16 v[52:55], v[24:27], v[144:147], v[52:55]
  v_and_b32_dpp v24, v44, v4 row_newbcast:6 row_mask:0xf bank_mask:0xf
  v_and_b32_dpp v25, v44, v5 row_newbcast:6 row_mask:0xf bank_mask:0xf
  v_and_b32_dpp v26, v44, v6 row_newbcast:6 row_mask:0xf bank_mask:0xf
  v_and_b32_dpp v27, v44, v7 row_newbcast:6 row_mask:0xf bank_mask:0xf
  s_waitcnt vmcnt(26)
  v_mfma_f32_16x16x32_bf16 v[52:55], v[28:31], v[148:151], v[52:55]
  v_and_b32_dpp v28, v44, v4 row_newbcast:7 row_mask:0xf bank_mask:0xf
  v_and_b32_dpp v29, v44, v5 row_newbcast:7 row_mask:0xf bank_mask:0xf
  v_and_b32_dpp v30, v44, v6 row_newbcast:7 row_mask:0xf bank_mask:0xf
  v_and_b32_dpp v31, v44, v7 row_newbcast:7 row_mask:0xf bank_mask:0xf
  s_waitcnt vmcnt(25)
  v_mfma_f32_16x16x32_bf16 v[52:55], v[24:27], v[152:155], v[52:55]
  v_and_b32_dpp v24, v44, v4 row_newbcast:8 row_mask:0xf bank_mask:0xf
  v_and_b32_dpp v25, v44, v5 row_newbcast:8 row_mask:0xf bank_mask:0xf
  v_and_b32_dpp v26, v44, v6 row_newbcast:8 row_mask:0xf bank_mask:0xf
  v_and_b32_dpp v27, v44, v7 row_newbcast:8 row_mask:0xf bank_mask:0xf
  s_waitcnt vmcnt(24)
  v_mfma_f32_16x16x32_bf16 v[52:55], v[28:31], v[156:159], v[52:55]
  v_and_b32_dpp v28, v44, v4 row_newbcast:9 row_mask:0xf bank_mask:0xf
  v_and_b32_dpp v29, v44, v5 row_newbcast:9 row_mask:0xf bank_mask:0xf
  v_and_b32_dpp v30, v44, v6 row_newbcast:9 row_mask:0xf bank_mask:0xf
  v_and_b32_dpp v31, v44, v7 row_newbcast:9 row_mask:0xf bank_mask:0xf
  s_waitcnt vmcnt(23)
  v_mfma_f32_16x16x32_bf16 v[52:55], v[24:27], v[160:163], v[52:55]
  v_and_b32_dpp v24, v44, v4 row_newbcast:10 row_mask:0xf bank_mask:0xf
  v_and_b32_dpp v25, v44, v5 row_newbcast:10 row_mask:0xf bank_mask:0xf
  v_and_b32_dpp v26, v44, v6 row_newbcast:10 row_mask:0xf bank_mask:0xf
  v_and_b32_dpp v27, v44, v7 row_newbcast:10 row_mask:0xf bank_mask:0xf
  s_waitcnt vmcnt(22)
  v_mfma_f32_16x16x32_bf16 v[52:55], v[28:31], v[164:167], v[52:55]
  v_and_b32_dpp v28, v44, v4 row_newbcast:11 row_mask:0xf bank_mask:0xf
  v_and_b32_dpp v29, v44, v5 row_newbcast:11 row_mask:0xf bank_mask:0xf
  v_and_b32_dpp v30, v44, v6 row_newbcast:11 row_mask:0xf bank_mask:0xf
  v_and_b32_dpp v31, v44, v7 row_newbcast:11 row_mask:0xf bank_mask:0xf
  s_waitcnt vmcnt(21)
  v_mfma_f32_16x16x32_bf16 v[52:55], v[24:27], v[168:171], v[52:55]
  v_and_b32_dpp v24, v44, v4 row_newbcast:12 row_mask:0xf bank_mask:0xf
  v_and_b32_dpp v25, v44, v5 row_newbcast:12 row_mask:0xf bank_mask:0xf
  v_and_b32_dpp v26, v44, v6 row_newbcast:12 row_mask:0xf bank_mask:0xf
  v_and_b32_dpp v27, v44, v7 row_newbcast:12 row_mask:0xf bank_mask:0xf
  s_waitcnt vmcnt(20)
  v_mfma_f32_16x16x32_bf16 v[52:55], v[28:31], v[172:175], v[52:55]
  v_and_b32_dpp v28, v44, v4 row_newbcast:13 row_mask:0xf bank_mask:0xf
  v_and_b32_dpp v29, v44, v5 row_newbcast:13 row_mask:0xf bank_mask:0xf
  v_and_b32_dpp v30, v44, v6 row_newbcast:13 row_mask:0xf bank_mask:0xf
  v_and_b32_dpp v31, v44, v7 row_newbcast:13 row_mask:0xf bank_mask:0xf
  s_waitcnt vmcnt(19)
  v_mfma_f32_16x16x32_bf16 v[52:55], v[24:27], v[176:179], v[52:55]
  v_and_b32_dpp v24, v44, v4 row_newbcast:14 row_mask:0xf bank_mask:0xf
  v_and_b32_dpp v25, v44, v5 row_newbcast:14 row_mask:0xf bank_mask:0xf
  v_and_b32_dpp v26, v44, v6 row_newbcast:14 row_mask:0xf bank_mask:0xf
  v_and_b32_dpp v27, v44, v7 row_newbcast:14 row_mask:0xf bank_mask:0xf
  s_waitcnt vmcnt(18)
  v_mfma_f32_16x16x32_bf16 v[52:55], v[28:31], v[180:183], v[52:55]
  v_and_b32_dpp v28, v44, v4 row_newbcast:15 row_mask:0xf bank_mask:0xf
  v_and_b32_dpp v29, v44, v5 row_newbcast:15 row_mask:0xf bank_mask:0xf
  v_and_b32_dpp v30, v44, v6 row_newbcast:15 row_mask:0xf bank_mask:0xf
  v_and_b32_dpp v31, v44, v7 row_newbcast:15 row_mask:0xf bank_mask:0xf
  s_waitcnt vmcnt(17)
  v_mfma_f32_16x16x32_bf16 v[52:55], v[24:27], v[184:187], v[52:55]
  v_and_b32_dpp v24, v45, v4 row_newbcast:0 row_mask:0xf bank_mask:0xf
  v_and_b32_dpp v25, v45, v5 row_newbcast:0 row_mask:0xf bank_mask:0xf
  v_and_b32_dpp v26, v45, v6 row_newbcast:0 row_mask:0xf bank_mask:0xf
  v_and_b32_dpp v27, v45, v7 row_newbcast:0 row_mask:0xf bank_mask:0xf
  s_waitcnt vmcnt(16)
  v_mfma_f32_16x16x32_bf16 v[52:55], v[28:31], v[188:191], v[52:55]
  v_and_b32_dpp v28, v45, v4 row_newbcast:1 row_mask:0xf bank_mask:0xf
  v_and_b32_dpp v29, v45, v5 row_newbcast:1 row_mask:0xf bank_mask:0xf
  v_and_b32_dpp v30, v45, v6 row_newbcast:1 row_mask:0xf bank_mask:0xf
  v_and_b32_dpp v31, v45, v7 row_newbcast:1 row_mask:0xf bank_mask:0xf
  s_waitcnt vmcnt(15)
  v_mfma_f32_16x16x32_bf16 v[52:55], v[24:27], v[192:195], v[52:55]
  v_and_b32_dpp v24, v45, v4 row_newbcast:2 row_mask:0xf bank_mask:0xf
  v_and_b32_dpp v25, v45, v5 row_newbcast:2 row_mask:0xf bank_mask:0xf
  v_and_b32_dpp v26, v45, v6 row_newbcast:2 row_mask:0xf bank_mask:0xf
  v_and_b32_dpp v27, v45, v7 row_newbcast:2 row_mask:0xf bank_mask:0xf
  s_waitcnt vmcnt(14)
  v_mfma_f32_16x16x32_bf16 v[52:55], v[28:31], v[196:199], v[52:55]
  v_and_b32_dpp v28, v45, v4 row_newbcast:3 row_mask:0xf bank_mask:0xf
  v_and_b32_dpp v29, v45, v5 row_newbcast:3 row_mask:0xf bank_mask:0xf
  v_and_b32_dpp v30, v45, v6 row_newbcast:3 row_mask:0xf bank_mask:0xf
  v_and_b32_dpp v31, v45, v7 row_newbcast:3 row_mask:0xf bank_mask:0xf
  s_waitcnt vmcnt(13)
  v_mfma_f32_16x16x32_bf16 v[52:55], v[24:27], v[200:203], v[52:55]
  v_and_b32_dpp v24, v45, v4 row_newbcast:4 row_mask:0xf bank_mask:0xf
  v_and_b32_dpp v25, v45, v5 row_newbcast:4 row_mask:0xf bank_mask:0xf
  v_and_b32_dpp v26, v45, v6 row_newbcast:4 row_mask:0xf bank_mask:0xf
  v_and_b32_dpp v27, v45, v7 row_newbcast:4 row_mask:0xf bank_mask:0xf
  s_waitcnt vmcnt(12)
  v_mfma_f32_16x16x32_bf16 v[52:55], v[28:31], v[204:207], v[52:55]
  v_and_b32_dpp v28, v45, v4 row_newbcast:5 row_mask:0xf bank_mask:0xf
  v_and_b32_dpp v29, v45, v5 row_newbcast:5 row_mask:0xf bank_mask:0xf
  v_and_b32_dpp v30, v45, v6 row_newbcast:5 row_mask:0xf bank_mask:0xf
  v_and_b32_dpp v31, v45, v7 row_newbcast:5 row_mask:0xf bank_mask:0xf
  s_waitcnt vmcnt(11)
  v_mfma_f32_16x16x32_bf16 v[52:55], v[24:27], v[208:211], v[52:55]
  v_and_b32_dpp v24, v45, v4 row_newbcast:6 row_mask:0xf bank_mask:0xf
  v_and_b32_dpp v25, v45, v5 row_newbcast:6 row_mask:0xf bank_mask:0xf
  v_and_b32_dpp v26, v45, v6 row_newbcast:6 row_mask:0xf bank_mask:0xf
  v_and_b32_dpp v27, v45, v7 row_newbcast:6 row_mask:0xf bank_mask:0xf
  s_waitcnt vmcnt(10)
  v_mfma_f32_16x16x32_bf16 v[52:55], v[28:31], v[212:215], v[52:55]
  v_and_b32_dpp v28, v45, v4 row_newbcast:7 row_mask:0xf bank_mask:0xf
  v_and_b32_dpp v29, v45, v5 row_newbcast:7 row_mask:0xf bank_mask:0xf
  v_and_b32_dpp v30, v45, v6 row_newbcast:7 row_mask:0xf bank_mask:0xf
  v_and_b32_dpp v31, v45, v7 row_newbcast:7 row_mask:0xf bank_mask:0xf
  s_waitcnt vmcnt(9)
  v_mfma_f32_16x16x32_bf16 v[52:55], v[24:27], v[216:219], v[52:55]
  v_and_b32_dpp v24, v45, v4 row_newbcast:8 row_mask:0xf bank_mask:0xf
  v_and_b32_dpp v25, v45, v5 row_newbcast:8 row_mask:0xf bank_mask:0xf
  v_and_b32_dpp v26, v45, v6 row_newbcast:8 row_mask:0xf bank_mask:0xf
  v_and_b32_dpp v27, v45, v7 row_newbcast:8 row_mask:0xf bank_mask:0xf
  s_waitcnt vmcnt(8)
  v_mfma_f32_16x16x32_bf16 v[52:55], v[28:31], v[220:223], v[52:55]
  v_and_b32_dpp v28, v45, v4 row_newbcast:9 row_mask:0xf bank_mask:0xf
  v_and_b32_dpp v29, v45, v5 row_newbcast:9 row_mask:0xf bank_mask:0xf
  v_and_b32_dpp v30, v45, v6 row_newbcast:9 row_mask:0xf bank_mask:0xf
  v_and_b32_dpp v31, v45, v7 row_newbcast:9 row_mask:0xf bank_mask:0xf
  s_waitcnt vmcnt(7)
  v_mfma_f32_16x16x32_bf16 v[52:55], v[24:27], v[224:227], v[52:55]
  v_and_b32_dpp v24, v45, v4 row_newbcast:10 row_mask:0xf bank_mask:0xf
  v_and_b32_dpp v25, v45, v5 row_newbcast:10 row_mask:0xf bank_mask:0xf
  v_and_b32_dpp v26, v45, v6 row_newbcast:10 row_mask:0xf bank_mask:0xf
  v_and_b32_dpp v27, v45, v7 row_newbcast:10 row_mask:0xf bank_mask:0xf
  s_waitcnt vmcnt(6)
  v_mfma_f32_16x16x32_bf16 v[52:55], v[28:31], v[228:231], v[52:55]
  v_and_b32_dpp v28, v45, v4 row_newbcast:11 row_mask:0xf bank_mask:0xf
  v_and_b32_dpp v29, v45, v5 row_newbcast:11 row_mask:0xf bank_mask:0xf
  v_and_b32_dpp v30, v45, v6 row_newbcast:11 row_mask:0xf bank_mask:0xf
  v_and_b32_dpp v31, v45, v7 row_newbcast:11 row_mask:0xf bank_mask:0xf
  s_waitcnt vmcnt(5)
  v_mfma_f32_16x16x32_bf16 v[52:55], v[24:27], v[232:235], v[52:55]
  v_and_b32_dpp v24, v45, v4 row_newbcast:12 row_mask:0xf bank_mask:0xf
  v_and_b32_dpp v25, v45, v5 row_newbcast:12 row_mask:0xf bank_mask:0xf
  v_and_b32_dpp v26, v45, v6 row_newbcast:12 row_mask:0xf bank_mask:0xf
  v_and_b32_dpp v27, v45, v7 row_newbcast:12 row_mask:0xf bank_mask:0xf
  s_waitcnt vmcnt(4)
  v_mfma_f32_16x16x32_bf16 v[52:55], v[28:31], v[236:239], v[52:55]
  v_and_b32_dpp v28, v45, v4 row_newbcast:13 row_mask:0xf bank_mask:0xf
  v_and_b32_dpp v29, v45, v5 row_newbcast:13 row_mask:0xf bank_mask:0xf
  v_and_b32_dpp v30, v45, v6 row_newbcast:13 row_mask:0xf bank_mask:0xf
  v_and_b32_dpp v31, v45, v7 row_newbcast:13 row_mask:0xf bank_mask:0xf
  s_waitcnt vmcnt(3)
  v_mfma_f32_16x16x32_bf16 v[52:55], v[24:27], v[240:243], v[52:55]
  v_and_b32_dpp v24, v45, v4 row_newbcast:14 row_mask:0xf bank_mask:0xf
  v_and_b32_dpp v25, v45, v5 row_newbcast:14 row_mask:0xf bank_mask:0xf
  v_and_b32_dpp v26, v45, v6 row_newbcast:14 row_mask:0xf bank_mask:0xf
  v_and_b32_dpp v27, v45, v7 row_newbcast:14 row_mask:0xf bank_mask:0xf
  s_waitcnt vmcnt(2)
  v_mfma_f32_16x16x32_bf16 v[52:55], v[28:31], v[244:247], v[52:55]
  v_and_b32_dpp v28, v45, v4 row_newbcast:15 row_mask:0xf bank_mask:0xf
  v_and_b32_dpp v29, v45, v5 row_newbcast:15 row_mask:0xf bank_mask:0xf
  v_and_b32_dpp v30, v45, v6 row_newbcast:15 row_mask:0xf bank_mask:0xf
  v_and_b32_dpp v31, v45, v7 row_newbcast:15 row_mask:0xf bank_mask:0xf
  s_waitcnt vmcnt(1)
  v_mfma_f32_16x16x32_bf16 v[52:55], v[24:27], v[248:251], v[52:55]
  s_nop 1
  s_waitcnt vmcnt(0)
  v_mfma_f32_16x16x32_bf16 v[52:55], v[28:31], v[252:255], v[52:55]
  s_lshl_b32 s7, s9, 9
  v_add_u32 v16, s7, v23
  v_mov_b32 v17, 1
  s_mov_b32 exec_hi, 0
  s_nop 5
  ds_write_b128 v16, v[52:55] offset:4608
  s_mov_b64 exec, 1
  ds_add_u32 v21, v17 offset:4180
  s_mov_b64 exec, -1
  s_lshl_b32 s7, s10, 17
  s_lshl_b32 s8, s9, 8
  s_add_u32 s7, s7, s8
  v_lshlrev_b32 v22, 10, v2
  v_lshlrev_b32 v18, 4, v1
  v_add3_u32 v22, v22, v18, s7
  s_mov_b32 s69, s68
  s_mul_i32 s8, s69, 4096
  buffer_load_dwordx4 v[128:131], v22, s[56:59], s8 offen sc1 nt
  s_add_u32 s69, s69, 1
  s_and_b32 s69, s69, 31
  s_mul_i32 s8, s69, 4096
  s_waitcnt vmcnt(1)
  buffer_load_dwordx4 v[132:135], v22, s[56:59], s8 offen sc1 nt
  s_add_u32 s69, s69, 1
  s_and_b32 s69, s69, 31
  s_mul_i32 s8, s69, 4096
  s_waitcnt vmcnt(1)
  buffer_load_dwordx4 v[136:139], v22, s[56:59], s8 offen sc1 nt
  s_add_u32 s69, s69, 1
  s_and_b32 s69, s69, 31
  s_mul_i32 s8, s69, 4096
  s_waitcnt vmcnt(1)
  buffer_load_dwordx4 v[140:143], v22, s[56:59], s8 offen sc1 nt
  s_add_u32 s69, s69, 1
  s_and_b32 s69, s69, 31
  s_mul_i32 s8, s69, 4096
  s_waitcnt vmcnt(1)
  buffer_load_dwordx4 v[144:147], v22, s[56:59], s8 offen sc1 nt
  s_add_u32 s69, s69, 1
  s_and_b32 s69, s69, 31
  s_mul_i32 s8, s69, 4096
  s_waitcnt vmcnt(1)
  buffer_load_dwordx4 v[148:151], v22, s[56:59], s8 offen sc1 nt
  s_add_u32 s69, s69, 1
  s_and_b32 s69, s69, 31
  s_mul_i32 s8, s69, 4096
  s_waitcnt vmcnt(1)
  buffer_load_dwordx4 v[152:155], v22, s[56:59], s8 offen sc1 nt
  s_add_u32 s69, s69, 1
  s_and_b32 s69, s69, 31
  s_mul_i32 s8, s69, 4096
  s_waitcnt vmcnt(1)
  buffer_load_dwordx4 v[156:159], v22, s[56:59], s8 offen sc1 nt
  s_add_u32 s69, s69, 1
  s_and_b32 s69, s69, 31
  s_mul_i32 s8, s69, 4096
  s_waitcnt vmcnt(1)
  buffer_load_dwordx4 v[160:163], v22, s[56:59], s8 offen sc1 nt
  s_add_u32 s69, s69, 1
  s_and_b32 s69, s69, 31
  s_mul_i32 s8, s69, 4096
  s_waitcnt vmcnt(1)
  buffer_load_dwordx4 v[164:167], v22, s[56:59], s8 offen sc1 nt
  s_add_u32 s69, s69, 1
  s_and_b32 s69, s69, 31
  s_mul_i32 s8, s69, 4096
  s_waitcnt vmcnt(1)
  buffer_load_dwordx4 v[168:171], v22, s[56:59], s8 offen sc1 nt
  s_add_u32 s69, s69, 1
  s_and_b32 s69, s69, 31
  s_mul_i32 s8, s69, 4096
  s_waitcnt vmcnt(1)
  buffer_load_dwordx4 v[172:175], v22, s[56:59], s8 offen sc1 nt
  s_add_u32 s69, s69, 1
  s_and_b32 s69, s69, 31
  s_mul_i32 s8, s69, 4096
  s_waitcnt vmcnt(1)
  buffer_load_dwordx4 v[176:179], v22, s[56:59], s8 offen sc1 nt
  s_add_u32 s69, s69, 1
  s_and_b32 s69, s69, 31
  s_mul_i32 s8, s69, 4096
  s_waitcnt vmcnt(1)
  buffer_load_dwordx4 v[180:183], v22, s[56:59], s8 offen sc1 nt
  s_add_u32 s69, s69, 1
  s_and_b32 s69, s69, 31
  s_mul_i32 s8, s69, 4096
  s_waitcnt vmcnt(1)
  buffer_load_dwordx4 v[184:187], v22, s[56:59], s8 offen sc1 nt
  s_add_u32 s69, s69, 1
  s_and_b32 s69, s69, 31
  s_mul_i32 s8, s69, 4096
  s_waitcnt vmcnt(1)
  buffer_load_dwordx4 v[188:191], v22, s[56:59], s8 offen sc1 nt
  s_add_u32 s69, s69, 1
  s_and_b32 s69, s69, 31
  s_mul_i32 s8, s69, 4096
  s_waitcnt vmcnt(1)
  buffer_load_dwordx4 v[192:195], v22, s[56:59], s8 offen sc1 nt
  s_add_u32 s69, s69, 1
  s_and_b32 s69, s69, 31
  s_mul_i32 s8, s69, 4096
  s_waitcnt vmcnt(1)
  buffer_load_dwordx4 v[196:199], v22, s[56:59], s8 offen sc1 nt
  s_add_u32 s69, s69, 1
  s_and_b32 s69, s69, 31
  s_mul_i32 s8, s69, 4096
  s_waitcnt vmcnt(1)
  buffer_load_dwordx4 v[200:203], v22, s[56:59], s8 offen sc1 nt
  s_add_u32 s69, s69, 1
  s_and_b32 s69, s69, 31
  s_mul_i32 s8, s69, 4096
  s_waitcnt vmcnt(1)
  buffer_load_dwordx4 v[204:207], v22, s[56:59], s8 offen sc1 nt
  s_add_u32 s69, s69, 1
  s_and_b32 s69, s69, 31
  s_mul_i32 s8, s69, 4096
  s_waitcnt vmcnt(1)
  buffer_load_dwordx4 v[208:211], v22, s[56:59], s8 offen sc1 nt
  s_add_u32 s69, s69, 1
  s_and_b32 s69, s69, 31
  s_mul_i32 s8, s69, 4096
  s_waitcnt vmcnt(1)
  buffer_load_dwordx4 v[212:215], v22, s[56:59], s8 offen sc1 nt
  s_add_u32 s69, s69, 1
  s_and_b32 s69, s69, 31
  s_mul_i32 s8, s69, 4096
  s_waitcnt vmcnt(1)
  buffer_load_dwordx4 v[216:219], v22, s[56:59], s8 offen sc1 nt
  s_add_u32 s69, s69, 1
  s_and_b32 s69, s69, 31
  s_mul_i32 s8, s69, 4096
  s_waitcnt vmcnt(1)
  buffer_load_dwordx4 v[220:223], v22, s[56:59], s8 offen sc1 nt
  s_add_u32 s69, s69, 1
  s_and_b32 s69, s69, 31
  s_mul_i32 s8, s69, 4096
  s_waitcnt vmcnt(1)
  buffer_load_dwordx4 v[224:227], v22, s[56:59], s8 offen sc1 nt
  s_add_u32 s69, s69, 1
  s_and_b32 s69, s69, 31
  s_mul_i32 s8, s69, 4096
  s_waitcnt vmcnt(1)
  buffer_load_dwordx4 v[228:231], v22, s[56:59], s8 offen sc1 nt
  s_add_u32 s69, s69, 1
  s_and_b32 s69, s69, 31
  s_mul_i32 s8, s69, 4096
  s_waitcnt vmcnt(1)
  buffer_load_dwordx4 v[232:235], v22, s[56:59], s8 offen sc1 nt
  s_add_u32 s69, s69, 1
  s_and_b32 s69, s69, 31
  s_mul_i32 s8, s69, 4096
  s_waitcnt vmcnt(1)
  buffer_load_dwordx4 v[236:239], v22, s[56:59], s8 offen sc1 nt
  s_add_u32 s69, s69, 1
  s_and_b32 s69, s69, 31
  s_mul_i32 s8, s69, 4096
  s_waitcnt vmcnt(1)
  buffer_load_dwordx4 v[240:243], v22, s[56:59], s8 offen sc1 nt
  s_add_u32 s69, s69, 1
  s_and_b32 s69, s69, 31
  s_mul_i32 s8, s69, 4096
  s_waitcnt vmcnt(1)
  buffer_load_dwordx4 v[244:247], v22, s[56:59], s8 offen sc1 nt
  s_add_u32 s69, s69, 1
  s_and_b32 s69, s69, 31
  s_mul_i32 s8, s69, 4096
  s_waitcnt vmcnt(1)
  buffer_load_dwordx4 v[248:251], v22, s[56:59], s8 offen sc1 nt
  s_add_u32 s69, s69, 1
  s_and_b32 s69, s69, 31
  s_mul_i32 s8, s69, 4096
  s_waitcnt vmcnt(1)
  buffer_load_dwordx4 v[252:255], v22, s[56:59], s8 offen sc1 nt
  s_waitcnt vmcnt(1)
  s_mov_b32 s11, 0
L_fc_60:
  ds_read_b32 v17, v21 offset:4180
  s_waitcnt lgkmcnt(0)
  v_cmp_ne_u32 vcc, 4, v17
  s_add_u32 s11, s11, 1
  s_cmp_ge_u32 s11, 4000000
  s_cbranch_scc1 L_fcd_61
  s_cbranch_vccz L_fcd_61
  s_sleep 8
  s_branch L_fc_60
L_fcd_61:
  ds_read_b32 v64, v46 offset:4608
  ds_read_b32 v65, v80 offset:4608
  ds_read_b32 v66, v46 offset:5120
  ds_read_b32 v67, v80 offset:5120
  ds_read_b32 v68, v46 offset:5632
  ds_read_b32 v69, v80 offset:5632
  ds_read_b32 v70, v46 offset:6144
  ds_read_b32 v71, v80 offset:6144
  s_waitcnt lgkmcnt(0)
  v_add_f32 v64, v64, v66
  v_add_f32 v68, v68, v70
  v_add_f32 v64, v64, v68
  v_cvt_pk_bf16_f32 v64, v64, v64
  v_and_b32 v64, 0xffff0000, v64
  v_lshlrev_b32 v72, 16, v72
  v_add_f32 v64, v64, v72
  v_cvt_pk_bf16_f32 v64, v64, v64
  v_and_b32 v64, 0xffff0000, v64
  v_cmp_lt_f32 vcc, 0, v64
  s_nop 1
  v_cndmask_b32 v64, 0, v64, vcc
  v_mul_f32 v64, v64, v64
  v_cvt_pk_bf16_f32 v74, v64, v64
  v_add_f32 v65, v65, v67
  v_add_f32 v69, v69, v71
  v_add_f32 v65, v65, v69
  v_cvt_pk_bf16_f32 v65, v65, v65
  v_and_b32 v65, 0xffff0000, v65
  v_lshlrev_b32 v73, 16, v73
  v_add_f32 v65, v65, v73
  v_cvt_pk_bf16_f32 v65, v65, v65
  v_and_b32 v65, 0xffff0000, v65
  v_cmp_lt_f32 vcc, 0, v65
  s_nop 1
  v_cndmask_b32 v65, 0, v65, vcc
  v_mul_f32 v65, v65, v65
  v_cvt_pk_bf16_f32 v75, v65, v65
  v_and_b32 v18, 31, v0
  v_lshlrev_b32 v18, 2, v18
  s_mov_b32 s11, 0
L_fl_62:
  buffer_load_dword v17, v18, s[60:63], 0 offen sc1
  s_waitcnt vmcnt(0)
  v_cmp_eq_u32 vcc, 0, v17
  s_add_u32 s11, s11, 1
  s_cmp_ge_u32 s11, 1000000
  s_cbranch_scc1 L_fld_63
  s_cbranch_vccz L_fld_63
  s_sleep 64
  s_branch L_fl_62
L_fld_63:
  v_and_b32_dpp v24, v74, v4 row_newbcast:0 row_mask:0xf bank_mask:0xf
  v_and_b32_dpp v25, v74, v5 row_newbcast:0 row_mask:0xf bank_mask:0xf
  v_and_b32_dpp v26, v74, v6 row_newbcast:0 row_mask:0xf bank_mask:0xf
  v_and_b32_dpp v27, v74, v7 row_newbcast:0 row_mask:0xf bank_mask:0xf
  v_and_b32_dpp v28, v74, v4 row_newbcast:1 row_mask:0xf bank_mask:0xf
  v_and_b32_dpp v29, v74, v5 row_newbcast:1 row_mask:0xf bank_mask:0xf
  v_and_b32_dpp v30, v74, v6 row_newbcast:1 row_mask:0xf bank_mask:0xf
  v_and_b32_dpp v31, v74, v7 row_newbcast:1 row_mask:0xf bank_mask:0xf
  v_mfma_f32_16x16x32_bf16 v[52:55], v[24:27], v[128:131], 0
  v_and_b32_dpp v24, v74, v4 row_newbcast:2 row_mask:0xf bank_mask:0xf
  v_and_b32_dpp v25, v74, v5 row_newbcast:2 row_mask:0xf bank_mask:0xf
  v_and_b32_dpp v26, v74, v6 row_newbcast:2 row_mask:0xf bank_mask:0xf
  v_and_b32_dpp v27, v74, v7 row_newbcast:2 row_mask:0xf bank_mask:0xf
  v_mfma_f32_16x16x32_bf16 v[52:55], v[28:31], v[132:135], v[52:55]
  v_and_b32_dpp v28, v74, v4 row_newbcast:3 row_mask:0xf bank_mask:0xf
  v_and_b32_dpp v29, v74, v5 row_newbcast:3 row_mask:0xf bank_mask:0xf
  v_and_b32_dpp v30, v74, v6 row_newbcast:3 row_mask:0xf bank_mask:0xf
  v_and_b32_dpp v31, v74, v7 row_newbcast:3 row_mask:0xf bank_mask:0xf
  v_mfma_f32_16x16x32_bf16 v[52:55], v[24:27], v[136:139], v[52:55]
  v_and_b32_dpp v24, v74, v4 row_newbcast:4 row_mask:0xf bank_mask:0xf
  v_and_b32_dpp v25, v74, v5 row_newbcast:4 row_mask:0xf bank_mask:0xf
  v_and_b32_dpp v26, v74, v6 row_newbcast:4 row_mask:0xf bank_mask:0xf
  v_and_b32_dpp v27, v74, v7 row_newbcast:4 row_mask:0xf bank_mask:0xf
  v_mfma_f32_16x16x32_bf16 v[52:55], v[28:31], v[140:143], v[52:55]
  v_and_b32_dpp v28, v74, v4 row_newbcast:5 row_mask:0xf bank_mask:0xf
  v_and_b32_dpp v29, v74, v5 row_newbcast:5 row_mask:0xf bank_mask:0xf
  v_and_b32_dpp v30, v74, v6 row_newbcast:5 row_mask:0xf bank_mask:0xf
  v_and_b32_dpp v31, v74, v7 row_newbcast:5 row_mask:0xf bank_mask:0xf
  v_mfma_f32_16x16x32_bf16 v[52:55], v[24:27], v[144:147], v[52:55]
  v_and_b32_dpp v24, v74, v4 row_newbcast:6 row_mask:0xf bank_mask:0xf
  v_and_b32_dpp v25, v74, v5 row_newbcast:6 row_mask:0xf bank_mask:0xf
  v_and_b32_dpp v26, v74, v6 row_newbcast:6 row_mask:0xf bank_mask:0xf
  v_and_b32_dpp v27, v74, v7 row_newbcast:6 row_mask:0xf bank_mask:0xf
  v_mfma_f32_16x16x32_bf16 v[52:55], v[28:31], v[148:151], v[52:55]
  v_and_b32_dpp v28, v74, v4 row_newbcast:7 row_mask:0xf bank_mask:0xf
  v_and_b32_dpp v29, v74, v5 row_newbcast:7 row_mask:0xf bank_mask:0xf
  v_and_b32_dpp v30, v74, v6 row_newbcast:7 row_mask:0xf bank_mask:0xf
  v_and_b32_dpp v31, v74, v7 row_newbcast:7 row_mask:0xf bank_mask:0xf
  v_mfma_f32_16x16x32_bf16 v[52:55], v[24:27], v[152:155], v[52:55]
  v_and_b32_dpp v24, v74, v4 row_newbcast:8 row_mask:0xf bank_mask:0xf
  v_and_b32_dpp v25, v74, v5 row_newbcast:8 row_mask:0xf bank_mask:0xf
  v_and_b32_dpp v26, v74, v6 row_newbcast:8 row_mask:0xf bank_mask:0xf
  v_and_b32_dpp v27, v74, v7 row_newbcast:8 row_mask:0xf bank_mask:0xf
  v_mfma_f32_16x16x32_bf16 v[52:55], v[28:31], v[156:159], v[52:55]
  v_and_b32_dpp v28, v74, v4 row_newbcast:9 row_mask:0xf bank_mask:0xf
  v_and_b32_dpp v29, v74, v5 row_newbcast:9 row_mask:0xf bank_mask:0xf
  v_and_b32_dpp v30, v74, v6 row_newbcast:9 row_mask:0xf bank_mask:0xf
  v_and_b32_dpp v31, v74, v7 row_newbcast:9 row_mask:0xf bank_mask:0xf
  v_mfma_f32_16x16x32_bf16 v[52:55], v[24:27], v[160:163], v[52:55]
  v_and_b32_dpp v24, v74, v4 row_newbcast:10 row_mask:0xf bank_mask:0xf
  v_and_b32_dpp v25, v74, v5 row_newbcast:10 row_mask:0xf bank_mask:0xf
  v_and_b32_dpp v26, v74, v6 row_newbcast:10 row_mask:0xf bank_mask:0xf
  v_and_b32_dpp v27, v74, v7 row_newbcast:10 row_mask:0xf bank_mask:0xf
  v_mfma_f32_16x16x32_bf16 v[52:55], v[28:31], v[164:167], v[52:55]
  v_and_b32_dpp v28, v74, v4 row_newbcast:11 row_mask:0xf bank_mask:0xf
  v_and_b32_dpp v29, v74, v5 row_newbcast:11 row_mask:0xf bank_mask:0xf
  v_and_b32_dpp v30, v74, v6 row_newbcast:11 row_mask:0xf bank_mask:0xf
  v_and_b32_dpp v31, v74, v7 row_newbcast:11 row_mask:0xf bank_mask:0xf
  v_mfma_f32_16x16x32_bf16 v[52:55], v[24:27], v[168:171], v[52:55]
  v_and_b32_dpp v24, v74, v4 row_newbcast:12 row_mask:0xf bank_mask:0xf
  v_and_b32_dpp v25, v74, v5 row_newbcast:12 row_mask:0xf bank_mask:0xf
  v_and_b32_dpp v26, v74, v6 row_newbcast:12 row_mask:0xf bank_mask:0xf
  v_and_b32_dpp v27, v74, v7 row_newbcast:12 row_mask:0xf bank_mask:0xf
  v_mfma_f32_16x16x32_bf16 v[52:55], v[28:31], v[172:175], v[52:55]
  v_and_b32_dpp v28, v74, v4 row_newbcast:13 row_mask:0xf bank_mask:0xf
  v_and_b32_dpp v29, v74, v5 row_newbcast:13 row_mask:0xf bank_mask:0xf
  v_and_b32_dpp v30, v74, v6 row_newbcast:13 row_mask:0xf bank_mask:0xf
  v_and_b32_dpp v31, v74, v7 row_newbcast:13 row_mask:0xf bank_mask:0xf
  v_mfma_f32_16x16x32_bf16 v[52:55], v[24:27], v[176:179], v[52:55]
  v_and_b32_dpp v24, v74, v4 row_newbcast:14 row_mask:0xf bank_mask:0xf
  v_and_b32_dpp v25, v74, v5 row_newbcast:14 row_mask:0xf bank_mask:0xf
  v_and_b32_dpp v26, v74, v6 row_newbcast:14 row_mask:0xf bank_mask:0xf
  v_and_b32_dpp v27, v74, v7 row_newbcast:14 row_mask:0xf bank_mask:0xf
  v_mfma_f32_16x16x32_bf16 v[52:55], v[28:31], v[180:183], v[52:55]
  v_and_b32_dpp v28, v74, v4 row_newbcast:15 row_mask:0xf bank_mask:0xf
  v_and_b32_dpp v29, v74, v5 row_newbcast:15 row_mask:0xf bank_mask:0xf
  v_and_b32_dpp v30, v74, v6 row_newbcast:15 row_mask:0xf bank_mask:0xf
  v_and_b32_dpp v31, v74, v7 row_newbcast:15 row_mask:0xf bank_mask:0xf
  v_mfma_f32_16x16x32_bf16 v[52:55], v[24:27], v[184:187], v[52:55]
  v_and_b32_dpp v24, v75, v4 row_newbcast:0 row_mask:0xf bank_mask:0xf
  v_and_b32_dpp v25, v75, v5 row_newbcast:0 row_mask:0xf bank_mask:0xf
  v_and_b32_dpp v26, v75, v6 row_newbcast:0 row_mask:0xf bank_mask:0xf
  v_and_b32_dpp v27, v75, v7 row_newbcast:0 row_mask:0xf bank_mask:0xf
  v_mfma_f32_16x16x32_bf16 v[52:55], v[28:31], v[188:191], v[52:55]
  v_and_b32_dpp v28, v75, v4 row_newbcast:1 row_mask:0xf bank_mask:0xf
  v_and_b32_dpp v29, v75, v5 row_newbcast:1 row_mask:0xf bank_mask:0xf
  v_and_b32_dpp v30, v75, v6 row_newbcast:1 row_mask:0xf bank_mask:0xf
  v_and_b32_dpp v31, v75, v7 row_newbcast:1 row_mask:0xf bank_mask:0xf
  v_mfma_f32_16x16x32_bf16 v[52:55], v[24:27], v[192:195], v[52:55]
  v_and_b32_dpp v24, v75, v4 row_newbcast:2 row_mask:0xf bank_mask:0xf
  v_and_b32_dpp v25, v75, v5 row_newbcast:2 row_mask:0xf bank_mask:0xf
  v_and_b32_dpp v26, v75, v6 row_newbcast:2 row_mask:0xf bank_mask:0xf
  v_and_b32_dpp v27, v75, v7 row_newbcast:2 row_mask:0xf bank_mask:0xf
  v_mfma_f32_16x16x32_bf16 v[52:55], v[28:31], v[196:199], v[52:55]
  v_and_b32_dpp v28, v75, v4 row_newbcast:3 row_mask:0xf bank_mask:0xf
  v_and_b32_dpp v29, v75, v5 row_newbcast:3 row_mask:0xf bank_mask:0xf
  v_and_b32_dpp v30, v75, v6 row_newbcast:3 row_mask:0xf bank_mask:0xf
  v_and_b32_dpp v31, v75, v7 row_newbcast:3 row_mask:0xf bank_mask:0xf
  v_mfma_f32_16x16x32_bf16 v[52:55], v[24:27], v[200:203], v[52:55]
  v_and_b32_dpp v24, v75, v4 row_newbcast:4 row_mask:0xf bank_mask:0xf
  v_and_b32_dpp v25, v75, v5 row_newbcast:4 row_mask:0xf bank_mask:0xf
  v_and_b32_dpp v26, v75, v6 row_newbcast:4 row_mask:0xf bank_mask:0xf
  v_and_b32_dpp v27, v75, v7 row_newbcast:4 row_mask:0xf bank_mask:0xf
  v_mfma_f32_16x16x32_bf16 v[52:55], v[28:31], v[204:207], v[52:55]
  v_and_b32_dpp v28, v75, v4 row_newbcast:5 row_mask:0xf bank_mask:0xf
  v_and_b32_dpp v29, v75, v5 row_newbcast:5 row_mask:0xf bank_mask:0xf
  v_and_b32_dpp v30, v75, v6 row_newbcast:5 row_mask:0xf bank_mask:0xf
  v_and_b32_dpp v31, v75, v7 row_newbcast:5 row_mask:0xf bank_mask:0xf
  v_mfma_f32_16x16x32_bf16 v[52:55], v[24:27], v[208:211], v[52:55]
  v_and_b32_dpp v24, v75, v4 row_newbcast:6 row_mask:0xf bank_mask:0xf
  v_and_b32_dpp v25, v75, v5 row_newbcast:6 row_mask:0xf bank_mask:0xf
  v_and_b32_dpp v26, v75, v6 row_newbcast:6 row_mask:0xf bank_mask:0xf
  v_and_b32_dpp v27, v75, v7 row_newbcast:6 row_mask:0xf bank_mask:0xf
  v_mfma_f32_16x16x32_bf16 v[52:55], v[28:31], v[212:215], v[52:55]
  v_and_b32_dpp v28, v75, v4 row_newbcast:7 row_mask:0xf bank_mask:0xf
  v_and_b32_dpp v29, v75, v5 row_newbcast:7 row_mask:0xf bank_mask:0xf
  v_and_b32_dpp v30, v75, v6 row_newbcast:7 row_mask:0xf bank_mask:0xf
  v_and_b32_dpp v31, v75, v7 row_newbcast:7 row_mask:0xf bank_mask:0xf
  v_mfma_f32_16x16x32_bf16 v[52:55], v[24:27], v[216:219], v[52:55]
  v_and_b32_dpp v24, v75, v4 row_newbcast:8 row_mask:0xf bank_mask:0xf
  v_and_b32_dpp v25, v75, v5 row_newbcast:8 row_mask:0xf bank_mask:0xf
  v_and_b32_dpp v26, v75, v6 row_newbcast:8 row_mask:0xf bank_mask:0xf
  v_and_b32_dpp v27, v75, v7 row_newbcast:8 row_mask:0xf bank_mask:0xf
  v_mfma_f32_16x16x32_bf16 v[52:55], v[28:31], v[220:223], v[52:55]
  v_and_b32_dpp v28, v75, v4 row_newbcast:9 row_mask:0xf bank_mask:0xf
  v_and_b32_dpp v29, v75, v5 row_newbcast:9 row_mask:0xf bank_mask:0xf
  v_and_b32_dpp v30, v75, v6 row_newbcast:9 row_mask:0xf bank_mask:0xf
  v_and_b32_dpp v31, v75, v7 row_newbcast:9 row_mask:0xf bank_mask:0xf
  v_mfma_f32_16x16x32_bf16 v[52:55], v[24:27], v[224:227], v[52:55]
  v_and_b32_dpp v24, v75, v4 row_newbcast:10 row_mask:0xf bank_mask:0xf
  v_and_b32_dpp v25, v75, v5 row_newbcast:10 row_mask:0xf bank_mask:0xf
  v_and_b32_dpp v26, v75, v6 row_newbcast:10 row_mask:0xf bank_mask:0xf
  v_and_b32_dpp v27, v75, v7 row_newbcast:10 row_mask:0xf bank_mask:0xf
  v_mfma_f32_16x16x32_bf16 v[52:55], v[28:31], v[228:231], v[52:55]
  v_and_b32_dpp v28, v75, v4 row_newbcast:11 row_mask:0xf bank_mask:0xf
  v_and_b32_dpp v29, v75, v5 row_newbcast:11 row_mask:0xf bank_mask:0xf
  v_and_b32_dpp v30, v75, v6 row_newbcast:11 row_mask:0xf bank_mask:0xf
  v_and_b32_dpp v31, v75, v7 row_newbcast:11 row_mask:0xf bank_mask:0xf
  v_mfma_f32_16x16x32_bf16 v[52:55], v[24:27], v[232:235], v[52:55]
  v_and_b32_dpp v24, v75, v4 row_newbcast:12 row_mask:0xf bank_mask:0xf
  v_and_b32_dpp v25, v75, v5 row_newbcast:12 row_mask:0xf bank_mask:0xf
  v_and_b32_dpp v26, v75, v6 row_newbcast:12 row_mask:0xf bank_mask:0xf
  v_and_b32_dpp v27, v75, v7 row_newbcast:12 row_mask:0xf bank_mask:0xf
  v_mfma_f32_16x16x32_bf16 v[52:55], v[28:31], v[236:239], v[52:55]
  v_and_b32_dpp v28, v75, v4 row_newbcast:13 row_mask:0xf bank_mask:0xf
  v_and_b32_dpp v29, v75, v5 row_newbcast:13 row_mask:0xf bank_mask:0xf
  v_and_b32_dpp v30, v75, v6 row_newbcast:13 row_mask:0xf bank_mask:0xf
  v_and_b32_dpp v31, v75, v7 row_newbcast:13 row_mask:0xf bank_mask:0xf
  v_mfma_f32_16x16x32_bf16 v[52:55], v[24:27], v[240:243], v[52:55]
  v_and_b32_dpp v24, v75, v4 row_newbcast:14 row_mask:0xf bank_mask:0xf
  v_and_b32_dpp v25, v75, v5 row_newbcast:14 row_mask:0xf bank_mask:0xf
  v_and_b32_dpp v26, v75, v6 row_newbcast:14 row_mask:0xf bank_mask:0xf
  v_and_b32_dpp v27, v75, v7 row_newbcast:14 row_mask:0xf bank_mask:0xf
  v_mfma_f32_16x16x32_bf16 v[52:55], v[28:31], v[244:247], v[52:55]
  v_and_b32_dpp v28, v75, v4 row_newbcast:15 row_mask:0xf bank_mask:0xf
  v_and_b32_dpp v29, v75, v5 row_newbcast:15 row_mask:0xf bank_mask:0xf
  v_and_b32_dpp v30, v75, v6 row_newbcast:15 row_mask:0xf bank_mask:0xf
  v_and_b32_dpp v31, v75, v7 row_newbcast:15 row_mask:0xf bank_mask:0xf
  v_mfma_f32_16x16x32_bf16 v[52:55], v[24:27], v[248:251], v[52:55]
  s_nop 1
  v_mfma_f32_16x16x32_bf16 v[52:55], v[28:31], v[252:255], v[52:55]
  s_nop 7
  v_min_u32 v60, -2, v52
  v_min_u32 v61, -2, v53
  v_min_u32 v62, -2, v54
  v_min_u32 v63, -2, v55
  s_lshl_b32 s7, s10, 11
  s_lshl_b32 s8, s9, 9
  s_add_u32 s7, s7, s8
  s_add_u32 s7, s7, 589824
  s_mov_b32 exec_hi, 0
  buffer_store_dwordx4 v[60:63], v23, s[64:67], s7 offen sc1
  s_mov_b32 exec_hi, -1
  s_nop 1
L_noffn_59:
  s_mov_b32 s48, s24
  s_and_b32 s49, s25, 0xffff
  s_mov_b32 s50, 4194304
  s_mov_b32 s51, 0x20000
  s_lshl_b32 s7, s4, 17
  s_lshl_b32 s8, s9, 8
  s_add_u32 s7, s7, s8
  v_lshlrev_b32 v22, 10, v2
  v_lshlrev_b32 v18, 4, v1
  v_add3_u32 v22, v22, v18, s7
  s_mov_b32 s69, s68
  s_mul_i32 s8, s69, 4096
  buffer_load_dwordx4 v[128:131], v22, s[48:51], s8 offen sc1 nt
  s_add_u32 s69, s69, 1
  s_and_b32 s69, s69, 31
  s_mul_i32 s8, s69, 4096
  s_waitcnt vmcnt(3)
  buffer_load_dwordx4 v[132:135], v22, s[48:51], s8 offen sc1 nt
  s_add_u32 s69, s69, 1
  s_and_b32 s69, s69, 31
  s_mul_i32 s8, s69, 4096
  s_waitcnt vmcnt(3)
  buffer_load_dwordx4 v[136:139], v22, s[48:51], s8 offen sc1 nt
  s_add_u32 s69, s69, 1
  s_and_b32 s69, s69, 31
  s_mul_i32 s8, s69, 4096
  s_waitcnt vmcnt(3)
  buffer_load_dwordx4 v[140:143], v22, s[48:51], s8 offen sc1 nt
  s_add_u32 s69, s69, 1
  s_and_b32 s69, s69, 31
  s_mul_i32 s8, s69, 4096
  s_waitcnt vmcnt(3)
  buffer_load_dwordx4 v[144:147], v22, s[48:51], s8 offen sc1 nt
  s_add_u32 s69, s69, 1
  s_and_b32 s69, s69, 31
  s_mul_i32 s8, s69, 4096
  s_waitcnt vmcnt(3)
  buffer_load_dwordx4 v[148:151], v22, s[48:51], s8 offen sc1 nt
  s_add_u32 s69, s69, 1
  s_and_b32 s69, s69, 31
  s_mul_i32 s8, s69, 4096
  s_waitcnt vmcnt(3)
  buffer_load_dwordx4 v[152:155], v22, s[48:51], s8 offen sc1 nt
  s_add_u32 s69, s69, 1
  s_and_b32 s69, s69, 31
  s_mul_i32 s8, s69, 4096
  s_waitcnt vmcnt(3)
  buffer_load_dwordx4 v[156:159], v22, s[48:51], s8 offen sc1 nt
  s_add_u32 s69, s69, 1
  s_and_b32 s69, s69, 31
  s_mul_i32 s8, s69, 4096
  s_waitcnt vmcnt(3)
  buffer_load_dwordx4 v[160:163], v22, s[48:51], s8 offen sc1 nt
  s_add_u32 s69, s69, 1
  s_and_b32 s69, s69, 31
  s_mul_i32 s8, s69, 4096
  s_waitcnt vmcnt(3)
  buffer_load_dwordx4 v[164:167], v22, s[48:51], s8 offen sc1 nt
  s_add_u32 s69, s69, 1
  s_and_b32 s69, s69, 31
  s_mul_i32 s8, s69, 4096
  s_waitcnt vmcnt(3)
  buffer_load_dwordx4 v[168:171], v22, s[48:51], s8 offen sc1 nt
  s_add_u32 s69, s69, 1
  s_and_b32 s69, s69, 31
  s_mul_i32 s8, s69, 4096
  s_waitcnt vmcnt(3)
  buffer_load_dwordx4 v[172:175], v22, s[48:51], s8 offen sc1 nt
  s_add_u32 s69, s69, 1
  s_and_b32 s69, s69, 31
  s_mul_i32 s8, s69, 4096
  s_waitcnt vmcnt(3)
  buffer_load_dwordx4 v[176:179], v22, s[48:51], s8 offen sc1 nt
  s_add_u32 s69, s69, 1
  s_and_b32 s69, s69, 31
  s_mul_i32 s8, s69, 4096
  s_waitcnt vmcnt(3)
  buffer_load_dwordx4 v[180:183], v22, s[48:51], s8 offen sc1 nt
  s_add_u32 s69, s69, 1
  s_and_b32 s69, s69, 31
  s_mul_i32 s8, s69, 4096
  s_waitcnt vmcnt(3)
  buffer_load_dwordx4 v[184:187], v22, s[48:51], s8 offen sc1 nt
  s_add_u32 s69, s69, 1
  s_and_b32 s69, s69, 31
  s_mul_i32 s8, s69, 4096
  s_waitcnt vmcnt(3)
  buffer_load_dwordx4 v[188:191], v22, s[48:51], s8 offen sc1 nt
  s_add_u32 s69, s69, 1
  s_and_b32 s69, s69, 31
  s_mul_i32 s8, s69, 4096
  s_waitcnt vmcnt(3)
  buffer_load_dwordx4 v[192:195], v22, s[48:51], s8 offen sc1 nt
  s_add_u32 s69, s69, 1
  s_and_b32 s69, s69, 31
  s_mul_i32 s8, s69, 4096
  s_waitcnt vmcnt(3)
  buffer_load_dwordx4 v[196:199], v22, s[48:51], s8 offen sc1 nt
  s_add_u32 s69, s69, 1
  s_and_b32 s69, s69, 31
  s_mul_i32 s8, s69, 4096
  s_waitcnt vmcnt(3)
  buffer_load_dwordx4 v[200:203], v22, s[48:51], s8 offen sc1 nt
  s_add_u32 s69, s69, 1
  s_and_b32 s69, s69, 31
  s_mul_i32 s8, s69, 4096
  s_waitcnt vmcnt(3)
  buffer_load_dwordx4 v[204:207], v22, s[48:51], s8 offen sc1 nt
  s_add_u32 s69, s69, 1
  s_and_b32 s69, s69, 31
  s_mul_i32 s8, s69, 4096
  s_waitcnt vmcnt(3)
  buffer_load_dwordx4 v[208:211], v22, s[48:51], s8 offen sc1 nt
  s_add_u32 s69, s69, 1
  s_and_b32 s69, s69, 31
  s_mul_i32 s8, s69, 4096
  s_waitcnt vmcnt(3)
  buffer_load_dwordx4 v[212:215], v22, s[48:51], s8 offen sc1 nt
  s_add_u32 s69, s69, 1
  s_and_b32 s69, s69, 31
  s_mul_i32 s8, s69, 4096
  s_waitcnt vmcnt(3)
  buffer_load_dwordx4 v[216:219], v22, s[48:51], s8 offen sc1 nt
  s_add_u32 s69, s69, 1
  s_and_b32 s69, s69, 31
  s_mul_i32 s8, s69, 4096
  s_waitcnt vmcnt(3)
  buffer_load_dwordx4 v[220:223], v22, s[48:51], s8 offen sc1 nt
  s_add_u32 s69, s69, 1
  s_and_b32 s69, s69, 31
  s_mul_i32 s8, s69, 4096
  s_waitcnt vmcnt(3)
  buffer_load_dwordx4 v[224:227], v22, s[48:51], s8 offen sc1 nt
  s_add_u32 s69, s69, 1
  s_and_b32 s69, s69, 31
  s_mul_i32 s8, s69, 4096
  s_waitcnt vmcnt(3)
  buffer_load_dwordx4 v[228:231], v22, s[48:51], s8 offen sc1 nt
  s_add_u32 s69, s69, 1
  s_and_b32 s69, s69, 31
  s_mul_i32 s8, s69, 4096
  s_waitcnt vmcnt(3)
  buffer_load_dwordx4 v[232:235], v22, s[48:51], s8 offen sc1 nt
  s_add_u32 s69, s69, 1
  s_and_b32 s69, s69, 31
  s_mul_i32 s8, s69, 4096
  s_waitcnt vmcnt(3)
  buffer_load_dwordx4 v[236:239], v22, s[48:51], s8 offen sc1 nt
  s_add_u32 s69, s69, 1
  s_and_b32 s69, s69, 31
  s_mul_i32 s8, s69, 4096
  s_waitcnt vmcnt(3)
  buffer_load_dwordx4 v[240:243], v22, s[48:51], s8 offen sc1 nt
  s_add_u32 s69, s69, 1
  s_and_b32 s69, s69, 31
  s_mul_i32 s8, s69, 4096
  s_waitcnt vmcnt(3)
  buffer_load_dwordx4 v[244:247], v22, s[48:51], s8 offen sc1 nt
  s_add_u32 s69, s69, 1
  s_and_b32 s69, s69, 31
  s_mul_i32 s8, s69, 4096
  s_waitcnt vmcnt(3)
  buffer_load_dwordx4 v[248:251], v22, s[48:51], s8 offen sc1 nt
  s_add_u32 s69, s69, 1
  s_and_b32 s69, s69, 31
  s_mul_i32 s8, s69, 4096
  s_waitcnt vmcnt(3)
  buffer_load_dwordx4 v[252:255], v22, s[48:51], s8 offen sc1 nt
  s_waitcnt vmcnt(3)
  v_mov_b32 v16, 0x0100
  v_mov_b32 v17, 0x0302
  v_cmp_gt_u32 vcc, 8, v1
  s_nop 1
  v_cndmask_b32 v16, v17, v16, vcc
  v_lshlrev_b32 v17, 16, v16
  v_or_b32 v16, v16, v17
  v_and_b32 v17, 7, v1
  v_lshrrev_b32 v18, 1, v17
  v_and_b32 v17, 1, v1
  v_lshlrev_b32 v17, 4, v17
  v_mov_b32 v60, 0xffff
  v_lshlrev_b32 v17, v17, v60
  v_mov_b32 v60, 0x0c0c0c0c
  v_bfi_b32 v16, v17, v16, v60
  v_cmp_eq_u32 vcc, 0, v18
  s_nop 1
  v_cndmask_b32 v56, v60, v16, vcc
  v_cmp_eq_u32 vcc, 1, v18
  s_nop 1
  v_cndmask_b32 v57, v60, v16, vcc
  v_cmp_eq_u32 vcc, 2, v18
  s_nop 1
  v_cndmask_b32 v58, v60, v16, vcc
  v_cmp_eq_u32 vcc, 3, v18
  s_nop 1
  v_cndmask_b32 v59, v60, v16, vcc
  v_lshrrev_b32 v47, 2, v0
  v_lshlrev_b32 v47, 11, v47
  v_and_b32 v16, 3, v0
  v_lshlrev_b32 v16, 4, v16
  v_add_u32 v47, v47, v16
  s_cmp_lg_u32 s9, 0
  s_cbranch_scc1 L_nosync_64
  v_lshrrev_b32 v16, 2, v0
  v_lshlrev_b32 v16, 5, v16
  s_and_b32 s7, s2, 31
  v_add_u32 v16, s7, v16
  v_and_b32 v16, 255, v16
  v_lshlrev_b32 v16, 7, v16
  v_and_b32 v17, 3, v0
  v_lshlrev_b32 v17, 3, v17
  v_add_u32 v16, v16, v17
  v_mul_u32_u24 v17, 15, v1
  v_add_u32 v17, 1, v17
  v_add_u32 v17, s2, v17
  v_and_b32 v17, 255, v17
  v_lshlrev_b32 v17, 7, v17
  v_add_u32 v17, 64, v17
  v_cmp_gt_u32 vcc, 32, v0
  s_nop 1
  v_cndmask_b32 v64, v17, v16, vcc
  s_lshl_b32 s7, s2, 7
  v_lshlrev_b32 v65, 3, v1
  v_add_u32 v65, s7, v65
  v_mov_b32 v66, -1
  v_mov_b32 v67, -1
  s_mov_b32 s11, 32768
  v_and_b32 v18, 3, v0
  v_lshlrev_b32 v18, 4, v18
  s_mov_b32 s10, 0
L_ms_65:
  ds_read_b32 v16, v21 offset:4192
  s_waitcnt lgkmcnt(0)
  v_readfirstlane_b32 s8, v16
  s_add_u32 s10, s10, 1
  s_cmp_ge_u32 s10, 4000000
  s_cbranch_scc1 L_msd_66
  s_cmp_ge_u32 s8, 16
  s_cbranch_scc1 L_msd_66
  s_sleep 12
  s_branch L_ms_65
L_msd_66:
  v_and_b32 v16, 31, v0
  v_lshlrev_b32 v16, 2, v16
  s_mov_b32 s10, 0
L_fl_68:
  buffer_load_dword v17, v16, s[60:63], 0 offen sc1
  s_waitcnt vmcnt(0)
  v_cmp_eq_u32 vcc, 0, v17
  s_add_u32 s10, s10, 1
  s_cmp_ge_u32 s10, 1000000
  s_cbranch_scc1 L_fld_69
  s_cbranch_vccz L_fld_69
  s_sleep 64
  s_branch L_fl_68
L_fld_69:
  s_cmp_ge_u32 s8, 32
  s_cbranch_scc1 L_msn_67
  s_mov_b64 exec, 0xfff0
  v_mov_b32 v66, 16
  v_mov_b32 v67, 16
  s_mov_b64 exec, 0xffff
  buffer_store_dwordx2 v[66:67], v65, s[64:67], s11 offen sc1
  s_mov_b32 s10, 0
L_rd_70:
  s_mov_b32 exec_lo, 0
  s_mov_b32 exec_hi, 0xffff
  buffer_load_dwordx2 v[68:69], v64, s[64:67], s11 offen sc1
  s_waitcnt vmcnt(0)
  s_mov_b32 exec_lo, 0
  v_cmp_le_i32 vcc, 16, v68
  s_mov_b64 exec, -1
  s_nop 3
  s_bcnt1_i32_b64 s8, vcc
  s_max_u32 s8, s8, 4
  s_sub_u32 s8, s8, 4
  s_mul_i32 s8, s8, 171
  s_add_u32 s8, s8, 128
  s_lshr_b32 s8, s8, 8
  s_min_u32 s8, s8, 16
  s_add_u32 s8, s8, 18
  v_mov_b32 v16, s8
  ds_write_b32 v21, v16 offset:4184
L_msn_67:
  s_mov_b32 s10, 0
L_ms_72:
  ds_read_b128 v[68:71], v18 offset:4096
  s_waitcnt lgkmcnt(0)
  v_cmp_ne_u32 vcc, 1, v70
  s_add_u32 s10, s10, 1
  s_cmp_ge_u32 s10, 4000000
  s_cbranch_scc1 L_msd_73
  s_cbranch_vccz L_msd_73
  s_sleep 12
  s_branch L_ms_72
L_msd_73:
  s_mov_b64 exec, 0xf
  v_min_u32 v66, -2, v68
  v_min_u32 v67, -2, v69
  s_mov_b64 exec, 0xfff0
  v_mov_b32 v66, 32
  v_mov_b32 v67, 32
  s_mov_b64 exec, 0xffff
  buffer_store_dwordx2 v[66:67], v65, s[64:67], s11 offen sc1
  s_mov_b32 s10, 0
L_rd_75:
  s_mov_b32 exec_lo, 0
  s_mov_b32 exec_hi, 0xffff
  buffer_load_dwordx2 v[68:69], v64, s[64:67], s11 offen sc1
  s_waitcnt vmcnt(0)
  s_mov_b32 exec_lo, 0
  v_cmp_le_i32 vcc, 32, v68
  s_mov_b64 exec, -1
  s_nop 3
  s_bcnt1_i32_b64 s8, vcc
  s_max_u32 s8, s8, 4
  s_sub_u32 s8, s8, 4
  s_mul_i32 s8, s8, 171
  s_add_u32 s8, s8, 128
  s_lshr_b32 s8, s8, 8
  s_min_u32 s8, s8, 12
  s_add_u32 s8, s8, 34
  v_mov_b32 v16, s8
  ds_write_b32 v21, v16 offset:4184
L_msn_74:
  s_mov_b32 s10, 0
L_ms_77:
  ds_read_b32 v16, v21 offset:4192
  s_waitcnt lgkmcnt(0)
  v_readfirstlane_b32 s8, v16
  s_add_u32 s10, s10, 1
  s_cmp_ge_u32 s10, 4000000
  s_cbranch_scc1 L_msd_78
  s_cmp_ge_u32 s8, 44
  s_cbranch_scc1 L_msd_78
  s_sleep 12
  s_branch L_ms_77
L_msd_78:
  s_cmp_ge_u32 s8, 54
  s_cbranch_scc1 L_msn_79
  s_mov_b64 exec, 0xfff0
  v_mov_b32 v66, 44
  v_mov_b32 v67, 44
  s_mov_b64 exec, 0xffff
  buffer_store_dwordx2 v[66:67], v65, s[64:67], s11 offen sc1
  s_mov_b32 s10, 0
L_rd_80:
  s_mov_b32 exec_lo, 0
  s_mov_b32 exec_hi, 0xffff
  buffer_load_dwordx2 v[68:69], v64, s[64:67], s11 offen sc1
  s_waitcnt vmcnt(0)
  s_mov_b32 exec_lo, 0
  v_cmp_le_i32 vcc, 44, v68
  s_mov_b64 exec, -1
  s_nop 3
  s_bcnt1_i32_b64 s8, vcc
  s_max_u32 s8, s8, 4
  s_sub_u32 s8, s8, 4
  s_mul_i32 s8, s8, 171
  s_add_u32 s8, s8, 128
  s_lshr_b32 s8, s8, 8
  s_min_u32 s8, s8, 10
  s_add_u32 s8, s8, 46
  v_mov_b32 v16, s8
  ds_write_b32 v21, v16 offset:4184
L_msn_79:
  s_mov_b32 s10, 0
L_ms_82:
  ds_read_b32 v16, v21 offset:4192
  s_waitcnt lgkmcnt(0)
  v_readfirstlane_b32 s8, v16
  s_add_u32 s10, s10, 1
  s_cmp_ge_u32 s10, 4000000
  s_cbranch_scc1 L_msd_83
  s_cmp_ge_u32 s8, 54
  s_cbranch_scc1 L_msd_83
  s_sleep 12
  s_branch L_ms_82
L_msd_83:
  s_mov_b64 exec, 0xfff0
  v_mov_b32 v66, 54
  v_mov_b32 v67, 54
  s_mov_b64 exec, 0xffff
  buffer_store_dwordx2 v[66:67], v65, s[64:67], s11 offen sc1
  s_mov_b32 s10, 0
L_rd_85:
  s_mov_b32 exec_lo, -1
  s_mov_b32 exec_hi, 0xffff
  buffer_load_dwordx2 v[68:69], v64, s[64:67], s11 offen sc1
  s_waitcnt vmcnt(0)
  s_mov_b32 exec_lo, 0
  v_cmp_le_i32 vcc, 54, v68
  s_mov_b64 exec, -1
  s_nop 3
  s_bcnt1_i32_b64 s8, vcc
  s_max_u32 s8, s8, 4
  s_sub_u32 s8, s8, 4
  s_mul_i32 s8, s8, 126
  s_add_u32 s8, s8, 128
  s_lshr_b32 s8, s8, 8
  s_min_u32 s8, s8, 6
  s_add_u32 s8, s8, 56
  v_mov_b32 v16, s8
  ds_write_b32 v21, v16 offset:4184
  s_mov_b32 exec_hi, 0
  v_max_u32 v17, v68, v69
  v_cmp_eq_u32 vcc, -1, v17
  s_mov_b64 exec, -1
  s_add_u32 s10, s10, 1
  s_cmp_ge_u32 s10, 1000000
  s_cbranch_scc1 L_rdd_86
  s_cbranch_vccz L_rdd_86
  s_sleep 64
  s_branch L_rd_85
L_rdd_86:
  v_mov_b32 v70, v68
  s_nop 1
  v_max_f32_dpp v70, v70, v70 quad_perm:[1,0,3,2] row_mask:0xf bank_mask:0xf
  s_nop 1
  v_max_f32_dpp v70, v70, v70 quad_perm:[2,3,0,1] row_mask:0xf bank_mask:0xf
  s_nop 1
  v_max_f32_dpp v70, v70, v70 row_half_mirror row_mask:0xf bank_mask:0xf
  s_nop 1
  v_max_f32_dpp v70, v70, v70 row_mirror row_mask:0xf bank_mask:0xf
  v_mov_b32 v17, v70
  s_nop 1
  v_permlane16_swap_b32 v70, v17
  s_nop 0
  v_max_f32 v70, v70, v17
  v_sub_f32 v68, v68, v70
  v_mul_f32 v68, 0x3fb8aa3b, v68
  v_exp_f32 v68, v68
  s_nop 0
  v_mul_f32 v69, v69, v68
  s_nop 1
  v_add_f32_dpp v69, v69, v69 quad_perm:[1,0,3,2] row_mask:0xf bank_mask:0xf
  s_nop 1
  v_add_f32_dpp v69, v69, v69 quad_perm:[2,3,0,1] row_mask:0xf bank_mask:0xf
  s_nop 1
  v_add_f32_dpp v69, v69, v69 row_half_mirror row_mask:0xf bank_mask:0xf
  s_nop 1
  v_add_f32_dpp v69, v69, v69 row_mirror row_mask:0xf bank_mask:0xf
  v_mov_b32 v17, v69
  s_nop 1
  v_permlane16_swap_b32 v69, v17
  s_nop 0
  v_add_f32 v69, v69, v17
  v_rcp_f32 v69, v69
  s_nop 0
  v_mul_f32 v68, v68, v69
  v_and_b32 v16, 3, v0
  v_lshlrev_b32 v16, 2, v16
  s_lshl_b32 s8, s5, 2
  s_lshl_b64 s[12:13], 15, s8
  s_mov_b64 exec, s[12:13]
  ds_write_b32 v16, v68 offset:4160
  s_mov_b64 exec, -1
L_msn_84:
  s_mov_b32 s10, 0
L_ms_87:
  ds_read_b32 v16, v21 offset:4192
  s_waitcnt lgkmcnt(0)
  v_readfirstlane_b32 s8, v16
  s_add_u32 s10, s10, 1
  s_cmp_ge_u32 s10, 4000000
  s_cbranch_scc1 L_msd_88
  s_cmp_ge_u32 s8, 60
  s_cbranch_scc1 L_msd_88
  s_sleep 12
  s_branch L_ms_87
L_msd_88:
  s_mov_b64 exec, 0xfff0
  v_mov_b32 v66, 60
  v_mov_b32 v67, 60
  s_mov_b64 exec, 0xffff
  buffer_store_dwordx2 v[66:67], v65, s[64:67], s11 offen sc1
  s_mov_b32 s10, 0
L_rd_90:
  s_mov_b32 exec_lo, 0
  s_mov_b32 exec_hi, 0xffff
  buffer_load_dwordx2 v[68:69], v64, s[64:67], s11 offen sc1
  s_waitcnt vmcnt(0)
  s_mov_b32 exec_lo, 0
  v_cmp_le_i32 vcc, 60, v68
  s_mov_b64 exec, -1
  s_nop 3
  s_bcnt1_i32_b64 s8, vcc
  s_max_u32 s8, s8, 4
  s_sub_u32 s8, s8, 4
  s_mul_i32 s8, s8, 84
  s_add_u32 s8, s8, 128
  s_lshr_b32 s8, s8, 8
  s_min_u32 s8, s8, 4
  s_add_u32 s8, s8, 62
  v_mov_b32 v16, s8
  ds_write_b32 v21, v16 offset:4184
L_msn_89:
  s_mov_b64 exec, -1
L_nosync_64:
  s_cmp_lg_u32 s9, 1
  s_cbranch_scc1 L_nob_92
  s_cmp_ge_u32 s2, 32
  s_cbranch_scc1 L_nob_92
  s_mov_b32 s52, s34
  s_and_b32 s53, s35, 0xffff
  s_mov_b32 s54, 1024
  s_mov_b32 s55, 0x20000
  s_lshl_b32 s7, s2, 5
  v_lshlrev_b32 v16, 1, v1
  buffer_load_ushort v35, v16, s[44:47], s7 offen
  buffer_load_ushort v60, v16, s[52:55], s7 offen
  s_mov_b32 s10, 0
L_tr_93:
  ds_read_b32 v17, v21 offset:4176
  s_waitcnt lgkmcnt(0)
  v_cmp_ne_u32 vcc, 1, v17
  s_add_u32 s10, s10, 1
  s_cmp_ge_u32 s10, 4000000
  s_cbranch_scc1 L_trd_94
  s_cbranch_vccz L_trd_94
  s_sleep 32
  s_branch L_tr_93
L_trd_94:
  v_and_b32 v18, 31, v0
  v_lshlrev_b32 v18, 2, v18
  s_mov_b32 s10, 0
L_fl_95:
  buffer_load_dword v17, v18, s[60:63], 0 offen sc1
  s_waitcnt vmcnt(0)
  v_cmp_eq_u32 vcc, 0, v17
  s_add_u32 s10, s10, 1
  s_cmp_ge_u32 s10, 1000000
  s_cbranch_scc1 L_fld_96
  s_cbranch_vccz L_fld_96
  s_sleep 64
  s_branch L_fl_95
L_fld_96:
  s_lshl_b32 s7, s2, 6
  s_add_u32 s7, s7, 589824
  v_mov_b32 v64, 0
  v_mov_b32 v65, 0
  v_mov_b32 v66, 0
  v_mov_b32 v67, 0
  s_mov_b32 exec_hi, 16777215
  s_mov_b32 s10, 0
L_bg_97:
  buffer_load_dwordx4 v[64:67], v47, s[64:67], s7 offen sc1
  s_waitcnt vmcnt(0)
  v_max3_u32 v17, v64, v65, v66
  v_max_u32 v17, v17, v67
  v_cmp_eq_u32 vcc, -1, v17
  s_add_u32 s10, s10, 1
  s_cmp_ge_u32 s10, 1000000
  s_cbranch_scc1 L_bgd_98
  s_cbranch_vccz L_bgd_98
  s_sleep 64
  s_branch L_bg_97
L_bgd_98:
  s_mov_b32 exec_hi, -1
  s_nop 1
  v_add_f32_dpp v64, v64, v64 row_ror:4 row_mask:0xf bank_mask:0xf
  v_add_f32_dpp v65, v65, v65 row_ror:4 row_mask:0xf bank_mask:0xf
  v_add_f32_dpp v66, v66, v66 row_ror:4 row_mask:0xf bank_mask:0xf
  v_add_f32_dpp v67, v67, v67 row_ror:4 row_mask:0xf bank_mask:0xf
  s_nop 1
  v_add_f32_dpp v64, v64, v64 row_ror:8 row_mask:0xf bank_mask:0xf
  v_add_f32_dpp v65, v65, v65 row_ror:8 row_mask:0xf bank_mask:0xf
  v_add_f32_dpp v66, v66, v66 row_ror:8 row_mask:0xf bank_mask:0xf
  v_add_f32_dpp v67, v67, v67 row_ror:8 row_mask:0xf bank_mask:0xf
  v_mov_b32 v68, v64
  v_mov_b32 v69, v65
  v_mov_b32 v70, v66
  v_mov_b32 v71, v67
  s_nop 0
  v_permlane16_swap_b32 v64, v68
  v_permlane16_swap_b32 v65, v69
  v_permlane16_swap_b32 v66, v70
  v_permlane16_swap_b32 v67, v71
  v_add_f32 v64, v64, v68
  v_add_f32 v65, v65, v69
  v_add_f32 v66, v66, v70
  v_add_f32 v67, v67, v71
  v_mov_b32 v68, v64
  v_mov_b32 v69, v65
  v_mov_b32 v70, v66
  v_mov_b32 v71, v67
  s_nop 0
  v_permlane32_swap_b32 v64, v68
  v_permlane32_swap_b32 v65, v69
  v_permlane32_swap_b32 v66, v70
  v_permlane32_swap_b32 v67, v71
  v_add_f32 v64, v64, v68
  v_add_f32 v65, v65, v69
  v_add_f32 v66, v66, v70
  v_add_f32 v67, v67, v71
  v_lshlrev_b32 v16, 4, v0
  s_mov_b64 exec, 0xf
  ds_write_b128 v16, v[64:67] offset:4480
  s_mov_b64 exec, -1
  v_lshlrev_b32 v16, 2, v1
  s_waitcnt lgkmcnt(0)
  ds_read_b32 v34, v16 offset:4480
  v_lshlrev_b32 v35, 16, v35
  v_lshlrev_b32 v60, 16, v60
  s_waitcnt lgkmcnt(0)
  v_cvt_pk_bf16_f32 v34, v34, v34
  v_and_b32 v34, 0xffff0000, v34
  v_add_f32 v34, v34, v60
  v_cvt_pk_bf16_f32 v34, v34, v34
  v_and_b32 v34, 0xffff0000, v34
L_nob_92:
  s_lshl_b32 s7, s2, 11
  s_lshl_b32 s8, s9, 9
  s_add_u32 s7, s7, s8
  s_add_u32 s7, s7, 65536
  s_lshl_b32 s12, s9, 17
  s_lshl_b32 s8, s2, 6
  s_add_u32 s12, s12, s8
  s_add_u32 s12, s12, 65536
  s_add_u32 s13, s12, 32768
  s_add_u32 s14, s12, 65536
  s_add_u32 s15, s12, 98304
  s_waitcnt vmcnt(0) lgkmcnt(0)
  s_barrier
  ds_read_b128 v[60:63], v21 offset:4160
  ds_read_b32 v36, v46 offset:2048
  ds_read_b32 v37, v80 offset:2048
  ds_read_b32 v38, v46 offset:2560
  ds_read_b32 v39, v80 offset:2560
  ds_read_b32 v40, v46 offset:3072
  ds_read_b32 v41, v80 offset:3072
  ds_read_b32 v42, v46 offset:3584
  ds_read_b32 v43, v80 offset:3584
  s_waitcnt lgkmcnt(0)
  v_mul_f32 v44, v60, v36
  v_fmac_f32 v44, v61, v38
  v_fmac_f32 v44, v62, v40
  v_fmac_f32 v44, v63, v42
  v_mul_f32 v45, v60, v37
  v_fmac_f32 v45, v61, v39
  v_fmac_f32 v45, v62, v41
  v_fmac_f32 v45, v63, v43
  v_cvt_pk_bf16_f32 v17, v44, v44
  v_and_b32 v17, 0xffff0000, v17
  v_sub_f32 v17, v44, v17
  v_cvt_pk_bf16_f32 v44, v44, v17
  v_cvt_pk_bf16_f32 v18, v45, v45
  v_and_b32 v18, 0xffff0000, v18
  v_sub_f32 v18, v45, v18
  v_cvt_pk_bf16_f32 v45, v45, v18
  s_nop 1
  v_mov_b32_dpp v16, v44 row_newbcast:0 row_mask:0xf bank_mask:0xf
  v_perm_b32 v24, v16, v16, v56
  v_perm_b32 v25, v16, v16, v57
  v_perm_b32 v26, v16, v16, v58
  v_perm_b32 v27, v16, v16, v59
  v_mov_b32_dpp v16, v44 row_newbcast:1 row_mask:0xf bank_mask:0xf
  v_perm_b32 v28, v16, v16, v56
  v_perm_b32 v29, v16, v16, v57
  v_perm_b32 v30, v16, v16, v58
  v_perm_b32 v31, v16, v16, v59
  v_mfma_f32_16x16x32_bf16 v[52:55], v[24:27], v[128:131], 0
  v_mov_b32_dpp v16, v44 row_newbcast:2 row_mask:0xf bank_mask:0xf
  v_perm_b32 v24, v16, v16, v56
  v_perm_b32 v25, v16, v16, v57
  v_perm_b32 v26, v16, v16, v58
  v_perm_b32 v27, v16, v16, v59
  v_mfma_f32_16x16x32_bf16 v[52:55], v[28:31], v[132:135], v[52:55]
  v_mov_b32_dpp v16, v44 row_newbcast:3 row_mask:0xf bank_mask:0xf
  v_perm_b32 v28, v16, v16, v56
  v_perm_b32 v29, v16, v16, v57
  v_perm_b32 v30, v16, v16, v58
  v_perm_b32 v31, v16, v16, v59
  v_mfma_f32_16x16x32_bf16 v[52:55], v[24:27], v[136:139], v[52:55]
  v_mov_b32_dpp v16, v44 row_newbcast:4 row_mask:0xf bank_mask:0xf
  v_perm_b32 v24, v16, v16, v56
  v_perm_b32 v25, v16, v16, v57
  v_perm_b32 v26, v16, v16, v58
  v_perm_b32 v27, v16, v16, v59
  v_mfma_f32_16x16x32_bf16 v[52:55], v[28:31], v[140:143], v[52:55]
  v_mov_b32_dpp v16, v44 row_newbcast:5 row_mask:0xf bank_mask:0xf
  v_perm_b32 v28, v16, v16, v56
  v_perm_b32 v29, v16, v16, v57
  v_perm_b32 v30, v16, v16, v58
  v_perm_b32 v31, v16, v16, v59
  v_mfma_f32_16x16x32_bf16 v[52:55], v[24:27], v[144:147], v[52:55]
  v_mov_b32_dpp v16, v44 row_newbcast:6 row_mask:0xf bank_mask:0xf
  v_perm_b32 v24, v16, v16, v56
  v_perm_b32 v25, v16, v16, v57
  v_perm_b32 v26, v16, v16, v58
  v_perm_b32 v27, v16, v16, v59
  v_mfma_f32_16x16x32_bf16 v[52:55], v[28:31], v[148:151], v[52:55]
  v_mov_b32_dpp v16, v44 row_newbcast:7 row_mask:0xf bank_mask:0xf
  v_perm_b32 v28, v16, v16, v56
  v_perm_b32 v29, v16, v16, v57
  v_perm_b32 v30, v16, v16, v58
  v_perm_b32 v31, v16, v16, v59
  v_mfma_f32_16x16x32_bf16 v[52:55], v[24:27], v[152:155], v[52:55]
  v_mov_b32_dpp v16, v44 row_newbcast:8 row_mask:0xf bank_mask:0xf
  v_perm_b32 v24, v16, v16, v56
  v_perm_b32 v25, v16, v16, v57
  v_perm_b32 v26, v16, v16, v58
  v_perm_b32 v27, v16, v16, v59
  v_mfma_f32_16x16x32_bf16 v[52:55], v[28:31], v[156:159], v[52:55]
  v_mov_b32_dpp v16, v44 row_newbcast:9 row_mask:0xf bank_mask:0xf
  v_perm_b32 v28, v16, v16, v56
  v_perm_b32 v29, v16, v16, v57
  v_perm_b32 v30, v16, v16, v58
  v_perm_b32 v31, v16, v16, v59
  v_mfma_f32_16x16x32_bf16 v[52:55], v[24:27], v[160:163], v[52:55]
  v_mov_b32_dpp v16, v44 row_newbcast:10 row_mask:0xf bank_mask:0xf
  v_perm_b32 v24, v16, v16, v56
  v_perm_b32 v25, v16, v16, v57
  v_perm_b32 v26, v16, v16, v58
  v_perm_b32 v27, v16, v16, v59
  v_mfma_f32_16x16x32_bf16 v[52:55], v[28:31], v[164:167], v[52:55]
  v_mov_b32_dpp v16, v44 row_newbcast:11 row_mask:0xf bank_mask:0xf
  v_perm_b32 v28, v16, v16, v56
  v_perm_b32 v29, v16, v16, v57
  v_perm_b32 v30, v16, v16, v58
  v_perm_b32 v31, v16, v16, v59
  v_mfma_f32_16x16x32_bf16 v[52:55], v[24:27], v[168:171], v[52:55]
  v_mov_b32_dpp v16, v44 row_newbcast:12 row_mask:0xf bank_mask:0xf
  v_perm_b32 v24, v16, v16, v56
  v_perm_b32 v25, v16, v16, v57
  v_perm_b32 v26, v16, v16, v58
  v_perm_b32 v27, v16, v16, v59
  v_mfma_f32_16x16x32_bf16 v[52:55], v[28:31], v[172:175], v[52:55]
  v_mov_b32_dpp v16, v44 row_newbcast:13 row_mask:0xf bank_mask:0xf
  v_perm_b32 v28, v16, v16, v56
  v_perm_b32 v29, v16, v16, v57
  v_perm_b32 v30, v16, v16, v58
  v_perm_b32 v31, v16, v16, v59
  v_mfma_f32_16x16x32_bf16 v[52:55], v[24:27], v[176:179], v[52:55]
  v_mov_b32_dpp v16, v44 row_newbcast:14 row_mask:0xf bank_mask:0xf
  v_perm_b32 v24, v16, v16, v56
  v_perm_b32 v25, v16, v16, v57
  v_perm_b32 v26, v16, v16, v58
  v_perm_b32 v27, v16, v16, v59
  v_mfma_f32_16x16x32_bf16 v[52:55], v[28:31], v[180:183], v[52:55]
  v_mov_b32_dpp v16, v44 row_newbcast:15 row_mask:0xf bank_mask:0xf
  v_perm_b32 v28, v16, v16, v56
  v_perm_b32 v29, v16, v16, v57
  v_perm_b32 v30, v16, v16, v58
  v_perm_b32 v31, v16, v16, v59
  v_mfma_f32_16x16x32_bf16 v[52:55], v[24:27], v[184:187], v[52:55]
  v_mov_b32_dpp v16, v45 row_newbcast:0 row_mask:0xf bank_mask:0xf
  v_perm_b32 v24, v16, v16, v56
  v_perm_b32 v25, v16, v16, v57
  v_perm_b32 v26, v16, v16, v58
  v_perm_b32 v27, v16, v16, v59
  v_mfma_f32_16x16x32_bf16 v[52:55], v[28:31], v[188:191], v[52:55]
  v_mov_b32_dpp v16, v45 row_newbcast:1 row_mask:0xf bank_mask:0xf
  v_perm_b32 v28, v16, v16, v56
  v_perm_b32 v29, v16, v16, v57
  v_perm_b32 v30, v16, v16, v58
  v_perm_b32 v31, v16, v16, v59
  v_mfma_f32_16x16x32_bf16 v[52:55], v[24:27], v[192:195], v[52:55]
  v_mov_b32_dpp v16, v45 row_newbcast:2 row_mask:0xf bank_mask:0xf
  v_perm_b32 v24, v16, v16, v56
  v_perm_b32 v25, v16, v16, v57
  v_perm_b32 v26, v16, v16, v58
  v_perm_b32 v27, v16, v16, v59
  v_mfma_f32_16x16x32_bf16 v[52:55], v[28:31], v[196:199], v[52:55]
  v_mov_b32_dpp v16, v45 row_newbcast:3 row_mask:0xf bank_mask:0xf
  v_perm_b32 v28, v16, v16, v56
  v_perm_b32 v29, v16, v16, v57
  v_perm_b32 v30, v16, v16, v58
  v_perm_b32 v31, v16, v16, v59
  v_mfma_f32_16x16x32_bf16 v[52:55], v[24:27], v[200:203], v[52:55]
  v_mov_b32_dpp v16, v45 row_newbcast:4 row_mask:0xf bank_mask:0xf
  v_perm_b32 v24, v16, v16, v56
  v_perm_b32 v25, v16, v16, v57
  v_perm_b32 v26, v16, v16, v58
  v_perm_b32 v27, v16, v16, v59
  v_mfma_f32_16x16x32_bf16 v[52:55], v[28:31], v[204:207], v[52:55]
  v_mov_b32_dpp v16, v45 row_newbcast:5 row_mask:0xf bank_mask:0xf
  v_perm_b32 v28, v16, v16, v56
  v_perm_b32 v29, v16, v16, v57
  v_perm_b32 v30, v16, v16, v58
  v_perm_b32 v31, v16, v16, v59
  v_mfma_f32_16x16x32_bf16 v[52:55], v[24:27], v[208:211], v[52:55]
  v_mov_b32_dpp v16, v45 row_newbcast:6 row_mask:0xf bank_mask:0xf
  v_perm_b32 v24, v16, v16, v56
  v_perm_b32 v25, v16, v16, v57
  v_perm_b32 v26, v16, v16, v58
  v_perm_b32 v27, v16, v16, v59
  v_mfma_f32_16x16x32_bf16 v[52:55], v[28:31], v[212:215], v[52:55]
  v_mov_b32_dpp v16, v45 row_newbcast:7 row_mask:0xf bank_mask:0xf
  v_perm_b32 v28, v16, v16, v56
  v_perm_b32 v29, v16, v16, v57
  v_perm_b32 v30, v16, v16, v58
  v_perm_b32 v31, v16, v16, v59
  v_mfma_f32_16x16x32_bf16 v[52:55], v[24:27], v[216:219], v[52:55]
  v_mov_b32_dpp v16, v45 row_newbcast:8 row_mask:0xf bank_mask:0xf
  v_perm_b32 v24, v16, v16, v56
  v_perm_b32 v25, v16, v16, v57
  v_perm_b32 v26, v16, v16, v58
  v_perm_b32 v27, v16, v16, v59
  v_mfma_f32_16x16x32_bf16 v[52:55], v[28:31], v[220:223], v[52:55]
  v_mov_b32_dpp v16, v45 row_newbcast:9 row_mask:0xf bank_mask:0xf
  v_perm_b32 v28, v16, v16, v56
  v_perm_b32 v29, v16, v16, v57
  v_perm_b32 v30, v16, v16, v58
  v_perm_b32 v31, v16, v16, v59
  v_mfma_f32_16x16x32_bf16 v[52:55], v[24:27], v[224:227], v[52:55]
  v_mov_b32_dpp v16, v45 row_newbcast:10 row_mask:0xf bank_mask:0xf
  v_perm_b32 v24, v16, v16, v56
  v_perm_b32 v25, v16, v16, v57
  v_perm_b32 v26, v16, v16, v58
  v_perm_b32 v27, v16, v16, v59
  v_mfma_f32_16x16x32_bf16 v[52:55], v[28:31], v[228:231], v[52:55]
  v_mov_b32_dpp v16, v45 row_newbcast:11 row_mask:0xf bank_mask:0xf
  v_perm_b32 v28, v16, v16, v56
  v_perm_b32 v29, v16, v16, v57
  v_perm_b32 v30, v16, v16, v58
  v_perm_b32 v31, v16, v16, v59
  v_mfma_f32_16x16x32_bf16 v[52:55], v[24:27], v[232:235], v[52:55]
  v_mov_b32_dpp v16, v45 row_newbcast:12 row_mask:0xf bank_mask:0xf
  v_perm_b32 v24, v16, v16, v56
  v_perm_b32 v25, v16, v16, v57
  v_perm_b32 v26, v16, v16, v58
  v_perm_b32 v27, v16, v16, v59
  v_mfma_f32_16x16x32_bf16 v[52:55], v[28:31], v[236:239], v[52:55]
  v_mov_b32_dpp v16, v45 row_newbcast:13 row_mask:0xf bank_mask:0xf
  v_perm_b32 v28, v16, v16, v56
  v_perm_b32 v29, v16, v16, v57
  v_perm_b32 v30, v16, v16, v58
  v_perm_b32 v31, v16, v16, v59
  v_mfma_f32_16x16x32_bf16 v[52:55], v[24:27], v[240:243], v[52:55]
  v_mov_b32_dpp v16, v45 row_newbcast:14 row_mask:0xf bank_mask:0xf
  v_perm_b32 v24, v16, v16, v56
  v_perm_b32 v25, v16, v16, v57
  v_perm_b32 v26, v16, v16, v58
  v_perm_b32 v27, v16, v16, v59
  v_mfma_f32_16x16x32_bf16 v[52:55], v[28:31], v[244:247], v[52:55]
  v_mov_b32_dpp v16, v45 row_newbcast:15 row_mask:0xf bank_mask:0xf
  v_perm_b32 v28, v16, v16, v56
  v_perm_b32 v29, v16, v16, v57
  v_perm_b32 v30, v16, v16, v58
  v_perm_b32 v31, v16, v16, v59
  v_mfma_f32_16x16x32_bf16 v[52:55], v[24:27], v[248:251], v[52:55]
  s_nop 1
  v_mfma_f32_16x16x32_bf16 v[52:55], v[28:31], v[252:255], v[52:55]
  s_nop 7
  v_mov_b32 v60, v52
  v_mov_b32 v61, v53
  v_mov_b32 v62, v54
  v_mov_b32 v63, v55
  s_nop 0
  v_permlane32_swap_b32 v52, v60
  v_permlane32_swap_b32 v53, v61
  v_permlane32_swap_b32 v54, v62
  v_permlane32_swap_b32 v55, v63
  v_add_f32 v52, v52, v60
  v_add_f32 v53, v53, v61
  v_add_f32 v54, v54, v62
  v_add_f32 v55, v55, v63
  v_min_u32 v52, -2, v52
  v_min_u32 v53, -2, v53
  v_min_u32 v54, -2, v54
  v_min_u32 v55, -2, v55
  s_mov_b32 exec_hi, 0
  buffer_store_dwordx4 v[52:55], v23, s[64:67], s7 offen sc1
  s_mov_b32 exec_hi, -1
  s_cmp_ge_u32 s2, 32
  s_cbranch_scc1 L_hend_99
  s_mov_b32 s10, 0
L_gat_100:
  buffer_load_dwordx4 v[64:67], v47, s[64:67], s12 offen sc1
  buffer_load_dwordx4 v[68:71], v47, s[64:67], s13 offen sc1
  buffer_load_dwordx4 v[72:75], v47, s[64:67], s14 offen sc1
  buffer_load_dwordx4 v[76:79], v47, s[64:67], s15 offen sc1
  s_waitcnt vmcnt(0)
  v_max3_u32 v17, v64, v65, v66
  v_max3_u32 v17, v17, v67, v68
  v_max3_u32 v17, v17, v69, v70
  v_max3_u32 v17, v17, v71, v72
  v_max3_u32 v17, v17, v73, v74
  v_max3_u32 v17, v17, v75, v76
  v_max3_u32 v17, v17, v77, v78
  v_max_u32 v17, v17, v79
  v_cmp_eq_u32 vcc, -1, v17
  s_add_u32 s10, s10, 1
  s_cmp_ge_u32 s10, 1000000
  s_cbranch_scc1 L_gatd_101
  s_cbranch_vccnz L_gat_100
L_gatd_101:
  v_add_f32 v64, v64, v68
  v_add_f32 v72, v72, v76
  v_add_f32 v65, v65, v69
  v_add_f32 v73, v73, v77
  v_add_f32 v66, v66, v70
  v_add_f32 v74, v74, v78
  v_add_f32 v67, v67, v71
  v_add_f32 v75, v75, v79
  v_add_f32 v64, v64, v72
  v_add_f32 v65, v65, v73
  v_add_f32 v66, v66, v74
  v_add_f32 v67, v67, v75
  s_nop 1
  v_add_f32_dpp v64, v64, v64 row_ror:4 row_mask:0xf bank_mask:0xf
  v_add_f32_dpp v65, v65, v65 row_ror:4 row_mask:0xf bank_mask:0xf
  v_add_f32_dpp v66, v66, v66 row_ror:4 row_mask:0xf bank_mask:0xf
  v_add_f32_dpp v67, v67, v67 row_ror:4 row_mask:0xf bank_mask:0xf
  s_nop 1
  v_add_f32_dpp v64, v64, v64 row_ror:8 row_mask:0xf bank_mask:0xf
  v_add_f32_dpp v65, v65, v65 row_ror:8 row_mask:0xf bank_mask:0xf
  v_add_f32_dpp v66, v66, v66 row_ror:8 row_mask:0xf bank_mask:0xf
  v_add_f32_dpp v67, v67, v67 row_ror:8 row_mask:0xf bank_mask:0xf
  v_mov_b32 v68, v64
  v_mov_b32 v69, v65
  v_mov_b32 v70, v66
  v_mov_b32 v71, v67
  s_nop 0
  v_permlane16_swap_b32 v64, v68
  v_permlane16_swap_b32 v65, v69
  v_permlane16_swap_b32 v66, v70
  v_permlane16_swap_b32 v67, v71
  v_add_f32 v64, v64, v68
  v_add_f32 v65, v65, v69
  v_add_f32 v66, v66, v70
  v_add_f32 v67, v67, v71
  v_mov_b32 v68, v64
  v_mov_b32 v69, v65
  v_mov_b32 v70, v66
  v_mov_b32 v71, v67
  s_nop 0
  v_permlane32_swap_b32 v64, v68
  v_permlane32_swap_b32 v65, v69
  v_permlane32_swap_b32 v66, v70
  v_permlane32_swap_b32 v67, v71
  v_add_f32 v64, v64, v68
  v_add_f32 v65, v65, v69
  v_add_f32 v66, v66, v70
  v_add_f32 v67, v67, v71
  s_lshl_b32 s7, s9, 6
  v_lshlrev_b32 v16, 4, v0
  v_add_u32 v16, s7, v16
  s_mov_b64 exec, 0xf
  ds_write_b128 v16, v[64:67] offset:4224
  s_mov_b64 exec, -1
  s_waitcnt lgkmcnt(0)
  s_barrier
  s_cmp_lg_u32 s9, 1
  s_cbranch_scc1 L_hend_99
  v_lshlrev_b32 v16, 2, v1
  ds_read_b32 v64, v16 offset:4224
  ds_read_b32 v65, v16 offset:4288
  ds_read_b32 v66, v16 offset:4352
  ds_read_b32 v67, v16 offset:4416
  s_mov_b32 s44, s36
  s_and_b32 s45, s37, 0xffff
  s_mov_b32 s46, 1024
  s_mov_b32 s47, 0x20000
  s_lshl_b32 s7, s2, 5
  v_lshlrev_b32 v16, 1, v1
  s_waitcnt lgkmcnt(0)
  v_add_f32 v64, v64, v65
  v_add_f32 v66, v66, v67
  v_add_f32 v64, v64, v66
  v_cvt_pk_bf16_f32 v64, v64, v64
  v_and_b32 v64, 0xffff0000, v64
  v_add_f32 v64, v35, v64
  v_cvt_pk_bf16_f32 v64, v64, v64
  v_and_b32 v64, 0xffff0000, v64
  v_add_f32 v64, v64, v34
  v_cvt_pk_bf16_f32 v64, v64, v64
  s_mov_b64 exec, 0xffff
  buffer_store_short v64, v16, s[44:47], s7 offen
L_hend_99:
L_end:
  s_endpgm
.section .rodata,"a"
.p2align 6
.amdhsa_kernel parallel_sum__mha_block_cached__dense_activation_squared_relu__decode_kernel
  .amdhsa_next_free_vgpr 256
  .amdhsa_next_free_sgpr 100
  .amdhsa_accum_offset 256
  .amdhsa_group_segment_fixed_size 0
  .amdhsa_kernarg_size 104
  .amdhsa_user_sgpr_count 2
  .amdhsa_user_sgpr_kernarg_segment_ptr 1
  .amdhsa_system_sgpr_workgroup_id_x 1
.end_amdhsa_kernel
```
